```python
import torch

def _softmax(x, axis=-1):
    return torch.softmax(x, dim=axis)
def _gelu(x):
    return torch.nn.functional.gelu(x, approximate="tanh")
def _silu(x):
    return torch.nn.functional.silu(x)
def _sigmoid(x):
    return torch.sigmoid(x)
def _layernorm(x, axis=-1, eps=1e-5):
    m = x.mean(dim=axis, keepdim=True)
    v = x.var(dim=axis, keepdim=True, unbiased=False)
    return (x - m) / torch.sqrt(v + eps)
def _scatter_add(tgt, idx, src, axis=0):
    return tgt.clone().index_add_(axis, idx, src)
def _segment_sum(src, seg, n):
    out = torch.zeros((n,) + src.shape[1:], dtype=src.dtype)
    return out.index_add_(0, seg, src)
def _pad(x, pw):
    flat = tuple(v for pair in reversed(pw) for v in pair)
    return torch.nn.functional.pad(x, flat)

kernel_name = 'sequential_preLN__compressed_kv_cla__geglu_ffn__decode'

def setup_inputs():

    _w = (lambda a: (lambda t: t.to(torch.bfloat16) if t.is_floating_point() else t)(torch.as_tensor(a)))
    def _A_setup():
        B, H, Sq, Sk, D, M = 4, 32, 1, 4096, 128, 512
        Dc = 4 * D
        return {
            "x": _w((lambda *s: torch.randn(*s, dtype=torch.bfloat16) * 0.05)(B, Sq, M)),
            "c_kv": _w((lambda *s: torch.randn(*s, dtype=torch.bfloat16) * 0.4)(B, Sk, Dc)),
            "w_q": _w((lambda *s: torch.randn(*s, dtype=torch.bfloat16) * 3.2)(M, H, D) * (M ** -0.5)),
            "w_uk": _w((lambda *s: torch.randn(*s, dtype=torch.bfloat16) * 3.2)(Dc, H, D) * (Dc ** -0.5)),
            "w_uv": _w((lambda *s: torch.randn(*s, dtype=torch.bfloat16) * 0.4)(Dc, H, D) * (Dc ** -0.5)),
            "w_o": _w((lambda *s: torch.randn(*s, dtype=torch.bfloat16) * 0.4)(H, D, M) * ((H * D) ** -0.5)),
        }
    _A_in = _A_setup()

    def _B_setup():
        B, S, D, F = 4, 1, 512, 1792
        return {
            "x": _w((lambda *s: torch.randn(*s, dtype=torch.bfloat16) * 0.05)(B, S, D)),
            "w_gate": _w((lambda *s: torch.randn(*s, dtype=torch.bfloat16) * 0.05)(D, F)),
            "w_up": _w((lambda *s: torch.randn(*s, dtype=torch.bfloat16) * 0.05)(D, F)),
            "w_down": _w((lambda *s: torch.randn(*s, dtype=torch.bfloat16) * 0.05)(F, D)),
        }
    _B_in = _B_setup()

    return {
        "A_x": _A_in["x"],
        "A_c_kv": _A_in["c_kv"],
        "A_w_q": _A_in["w_q"],
        "A_w_uk": _A_in["w_uk"],
        "A_w_uv": _A_in["w_uv"],
        "A_w_o": _A_in["w_o"],
        "B_x": _B_in["x"],
        "B_w_gate": _B_in["w_gate"],
        "B_w_up": _B_in["w_up"],
        "B_w_down": _B_in["w_down"],
    }

def reference(A_x, A_c_kv, A_w_q, A_w_uk, A_w_uv, A_w_o, B_x, B_w_gate, B_w_up, B_w_down):
    def _A_ref(x, c_kv, w_q, w_uk, w_uv, w_o):
        B, Sq, M = x.shape[0], x.shape[1], x.shape[2]
        Sk = c_kv.shape[1]
        H, D = w_q.shape[1], w_q.shape[2]
        q = torch.einsum("bqm,mhd->bhqd", x, w_q)
        k = torch.einsum("bkc,chd->bhkd", c_kv, w_uk)
        v = torch.einsum("bkc,chd->bhkd", c_kv, w_uv)
        scores = torch.einsum("bhqd,bhkd->bhqk", q, k) * (D ** -0.5)
        off = Sk - Sq
        qi = torch.arange(Sq)[:, None]
        kj = torch.arange(Sk)[None, :]
        cmask = kj <= (qi + off)
        scores = torch.where(cmask[None, None], scores, -1e9)
        p = _softmax(scores, axis=-1)
        ctx = torch.einsum("bhqk,bhkd->bhqd", p, v)
        return torch.einsum("bhqd,hdm->bqm", ctx, w_o)

    def _B_ref(x, w_gate, w_up, w_down):
        return (_gelu(x @ w_gate) * (x @ w_up)) @ w_down

    x = A_x
    h = x + _A_ref(_layernorm(x, axis=-1), A_c_kv, A_w_q, A_w_uk, A_w_uv, A_w_o)
    h2 = h + _B_ref(_layernorm(h, axis=-1), B_w_gate, B_w_up, B_w_down)
    return h2
```

```asm
; @launch grid=(256,1,1) block=(512,1,1) lds=163840
.amdgcn_target "amdgcn-amd-amdhsa--gfx950"
.text
.globl sequential_preLN__compressed_kv_cla__geglu_ffn__decode_kernel
.p2align 8
.type sequential_preLN__compressed_kv_cla__geglu_ffn__decode_kernel,@function
sequential_preLN__compressed_kv_cla__geglu_ffn__decode_kernel:
    s_cmp_ge_u32 s2, 0x100
    s_cbranch_scc1 L_exit
    s_load_dwordx16 s[4:19], s[0:1], 0
    s_load_dwordx8 s[20:27], s[0:1], 64
    s_load_dwordx2 s[28:29], s[0:1], 96
    s_getpc_b64 s[40:41]
    s_lshr_b32 s42, s2, 3
    s_lshl_b32 s42, s42, 10
    v_lshlrev_b32 v4, 7, v0
    v_add_u32 v4, s42, v4
    v_min_u32 v4, L_exit-sequential_preLN__compressed_kv_cla__geglu_ffn__decode_kernel-64, v4
    v_cmp_gt_u32 vcc, 8, v0
    s_and_saveexec_b64 s[44:45], vcc
    s_cbranch_execz L_noct
    global_load_dword v24, v4, s[40:41]
L_noct:
    s_mov_b64 exec, -1
    v_lshrrev_b32 v4, 6, v0
    v_and_b32 v1, 63, v0
    v_readfirstlane_b32 s3, v4
    v_and_b32 v2, 15, v1
    v_lshrrev_b32 v3, 4, v1
    s_and_b32 s30, s2, 7
    s_lshr_b32 s31, s2, 3
    s_lshr_b32 s34, s30, 1
    s_and_b32 s35, s31, 1
    s_and_b32 s36, s30, 1
    s_lshl_b32 s36, s36, 4
    s_lshr_b32 s40, s31, 1
    s_add_u32 s36, s36, s40
    s_lshr_b32 s40, s31, 3
    s_lshl_b32 s37, s30, 2
    s_add_u32 s37, s37, s40
    s_bfe_u32 s38, s31, 0x20001
    s_cmp_lt_u32 s3, 4
    s_cbranch_scc1 L_noprio
    s_setprio 3
L_noprio:
    v_mov_b32 v26, 0
    v_mov_b32 v27, 0
    v_mov_b32 v28, 0
    v_mov_b32 v29, 0
    v_mov_b32 v62, 0
    v_mov_b32 v54, 0
    v_mov_b32 v55, 0
    v_mov_b32 v56, 0
    v_mov_b32 v249, 0
    v_mov_b32 v250, 0
    v_mov_b32 v253, 0
    s_waitcnt lgkmcnt(0)
    s_load_dword s32, s[28:29], 0
    s_cmp_eq_u32 s35, 1
    s_cbranch_scc1 L_nonp
    s_cmp_lt_u32 s3, 4
    s_cbranch_scc1 L_p_ld
    s_lshl_b32 s48, s38, 1
    s_and_b32 s40, s3, 1
    s_add_u32 s48, s48, s40
    s_and_b32 s40, s3, 3
    s_lshl_b32 s40, s40, 10
    v_lshlrev_b32 v9, 4, v1
    v_add_u32 v9, s40, v9
    global_load_dwordx4 v[4:7], v9, s[4:5]
    s_lshl_b32 s40, s48, 19
    s_lshl_b32 s41, s37, 8
    s_or_b32 s43, s40, s41
    s_cmp_ge_u32 s3, 6
    s_cbranch_scc1 L_w67a
    v_lshlrev_b32 v10, 14, v3
    v_lshl_add_u32 v10, v2, 4, v10
    v_add_u32 v10, s43, v10
    v_xor_b32 v11, 0x0, v10
    global_load_dwordx4 v[64:67], v11, s[8:9]
    v_xor_b32 v11, 0x2000, v10
    global_load_dwordx4 v[68:71], v11, s[8:9]
    v_xor_b32 v11, 0x10000, v10
    global_load_dwordx4 v[72:75], v11, s[8:9]
    v_xor_b32 v11, 0x12000, v10
    global_load_dwordx4 v[76:79], v11, s[8:9]
    v_xor_b32 v11, 0x20000, v10
    global_load_dwordx4 v[80:83], v11, s[8:9]
    v_xor_b32 v11, 0x22000, v10
    global_load_dwordx4 v[84:87], v11, s[8:9]
    v_xor_b32 v11, 0x30000, v10
    global_load_dwordx4 v[88:91], v11, s[8:9]
    v_xor_b32 v11, 0x32000, v10
    global_load_dwordx4 v[92:95], v11, s[8:9]
    v_xor_b32 v11, 0x40000, v10
    global_load_dwordx4 v[96:99], v11, s[8:9]
    v_xor_b32 v11, 0x42000, v10
    global_load_dwordx4 v[100:103], v11, s[8:9]
    v_xor_b32 v11, 0x50000, v10
    global_load_dwordx4 v[104:107], v11, s[8:9]
    v_xor_b32 v11, 0x52000, v10
    global_load_dwordx4 v[108:111], v11, s[8:9]
    v_xor_b32 v11, 0x60000, v10
    global_load_dwordx4 v[112:115], v11, s[8:9]
    v_xor_b32 v11, 0x62000, v10
    global_load_dwordx4 v[116:119], v11, s[8:9]
    v_xor_b32 v11, 0x70000, v10
    global_load_dwordx4 v[120:123], v11, s[8:9]
    v_xor_b32 v11, 0x72000, v10
    global_load_dwordx4 v[124:127], v11, s[8:9]
    s_call_b64 s[46:47], L_setup
    v_mov_b32 v8, 162304
    v_mov_b32 v9, 0
    ds_write_b32 v8, v9
    s_waitcnt vmcnt(16)
    s_branch L_ln
L_w67a:
    s_cmp_eq_u32 s3, 7
    s_cbranch_scc1 L_w7a
    s_lshl_b32 s40, s37, 2
    s_add_u32 s40, s40, s38
    s_mul_i32 s40, s40, 3072
    s_add_u32 s40, s40, 327680
    v_min_u32 v8, 23, v1
    v_lshlrev_b32 v8, 7, v8
    v_add_u32 v8, s40, v8
    global_load_dword v20, v8, s[28:29] sc1
    s_call_b64 s[46:47], L_setup
    s_waitcnt vmcnt(1)
    s_branch L_ln
L_w7a:
    s_call_b64 s[46:47], L_setup
    s_waitcnt vmcnt(0)
L_ln:
    v_lshlrev_b32 v8, 16, v4
    v_and_b32 v9, 0xffff0000, v4
    v_lshlrev_b32 v10, 16, v5
    v_and_b32 v11, 0xffff0000, v5
    v_lshlrev_b32 v12, 16, v6
    v_and_b32 v13, 0xffff0000, v6
    v_lshlrev_b32 v14, 16, v7
    v_and_b32 v15, 0xffff0000, v7
    v_add_f32 v16, v8, v9
    v_add_f32 v17, v10, v11
    v_add_f32 v18, v12, v13
    v_add_f32 v19, v14, v15
    v_add_f32 v16, v16, v17
    v_add_f32 v18, v18, v19
    v_add_f32 v16, v16, v18
    s_nop 1
    v_add_f32_dpp v16, v16, v16 row_ror:1 row_mask:0xf bank_mask:0xf
    s_nop 1
    v_add_f32_dpp v16, v16, v16 row_ror:2 row_mask:0xf bank_mask:0xf
    s_nop 1
    v_add_f32_dpp v16, v16, v16 row_ror:4 row_mask:0xf bank_mask:0xf
    s_nop 1
    v_add_f32_dpp v16, v16, v16 row_ror:8 row_mask:0xf bank_mask:0xf
    v_mov_b32 v17, v16
    s_nop 1
    v_permlane16_swap_b32 v17, v16
    v_add_f32 v16, v16, v17
    v_mov_b32 v17, v16
    s_nop 1
    v_permlane32_swap_b32 v17, v16
    v_add_f32 v16, v16, v17
    v_mul_f32 v16, 0x3b000000, v16
    v_sub_f32 v208, v8, v16
    v_sub_f32 v209, v9, v16
    v_sub_f32 v210, v10, v16
    v_sub_f32 v211, v11, v16
    v_sub_f32 v212, v12, v16
    v_sub_f32 v213, v13, v16
    v_sub_f32 v214, v14, v16
    v_sub_f32 v215, v15, v16
    v_mul_f32 v18, v208, v208
    v_fmac_f32 v18, v209, v209
    v_fmac_f32 v18, v210, v210
    v_fmac_f32 v18, v211, v211
    v_fmac_f32 v18, v212, v212
    v_fmac_f32 v18, v213, v213
    v_fmac_f32 v18, v214, v214
    v_fmac_f32 v18, v215, v215
    s_nop 1
    v_add_f32_dpp v18, v18, v18 row_ror:1 row_mask:0xf bank_mask:0xf
    s_nop 1
    v_add_f32_dpp v18, v18, v18 row_ror:2 row_mask:0xf bank_mask:0xf
    s_nop 1
    v_add_f32_dpp v18, v18, v18 row_ror:4 row_mask:0xf bank_mask:0xf
    s_nop 1
    v_add_f32_dpp v18, v18, v18 row_ror:8 row_mask:0xf bank_mask:0xf
    v_mov_b32 v17, v18
    s_nop 1
    v_permlane16_swap_b32 v17, v18
    v_add_f32 v18, v18, v17
    v_mov_b32 v17, v18
    s_nop 1
    v_permlane32_swap_b32 v17, v18
    v_add_f32 v18, v18, v17
    v_mul_f32 v18, 0x3b000000, v18
    v_cvt_pk_bf16_f32 v16, v16, v16
    v_and_b32 v16, 0xffff0000, v16
    v_cvt_pk_bf16_f32 v18, v18, v18
    v_and_b32 v18, 0xffff0000, v18
    v_add_f32 v18, 0x3727c5ac, v18
    v_cvt_pk_bf16_f32 v18, v18, v18
    v_and_b32 v18, 0xffff0000, v18
    v_sqrt_f32 v18, v18
    s_nop 0
    v_cvt_pk_bf16_f32 v18, v18, v18
    v_and_b32 v18, 0xffff0000, v18
    v_rcp_f32 v18, v18
    v_sub_f32 v8, v8, v16
    v_sub_f32 v9, v9, v16
    v_sub_f32 v10, v10, v16
    v_sub_f32 v11, v11, v16
    v_sub_f32 v12, v12, v16
    v_sub_f32 v13, v13, v16
    v_sub_f32 v14, v14, v16
    v_sub_f32 v15, v15, v16
    v_cvt_pk_bf16_f32 v4, v8, v9
    v_cvt_pk_bf16_f32 v5, v10, v11
    v_cvt_pk_bf16_f32 v6, v12, v13
    v_cvt_pk_bf16_f32 v7, v14, v15
    v_lshlrev_b32 v8, 16, v4
    v_and_b32 v9, 0xffff0000, v4
    v_lshlrev_b32 v10, 16, v5
    v_and_b32 v11, 0xffff0000, v5
    v_lshlrev_b32 v12, 16, v6
    v_and_b32 v13, 0xffff0000, v6
    v_lshlrev_b32 v14, 16, v7
    v_and_b32 v15, 0xffff0000, v7
    v_mul_f32 v8, v8, v18
    v_mul_f32 v9, v9, v18
    v_mul_f32 v10, v10, v18
    v_mul_f32 v11, v11, v18
    v_mul_f32 v12, v12, v18
    v_mul_f32 v13, v13, v18
    v_mul_f32 v14, v14, v18
    v_mul_f32 v15, v15, v18
    v_cvt_pk_bf16_f32 v4, v8, v9
    v_cvt_pk_bf16_f32 v5, v10, v11
    v_cvt_pk_bf16_f32 v6, v12, v13
    v_cvt_pk_bf16_f32 v7, v14, v15
    s_and_b32 s40, s3, 3
    s_lshl_b32 s40, s40, 10
    s_add_u32 s40, s40, 153600
    v_lshlrev_b32 v9, 4, v1
    v_add_u32 v9, s40, v9
    ds_write_b128 v9, v[4:7]
    s_cmp_ge_u32 s3, 6
    s_cbranch_scc1 L_w67b
    v_and_b32 v8, 1, v2
    v_cmp_eq_u32 vcc, 1, v8
    v_mov_b32 v10, 0x0c0c0100
    v_mov_b32 v9, 0x01000c0c
    v_mov_b32 v12, 0x0c0c0302
    v_mov_b32 v13, 0x03020c0c
    v_cndmask_b32 v10, v10, v9, vcc
    v_cndmask_b32 v12, v12, v13, vcc
    v_and_b32 v8, 2, v2
    v_cmp_eq_u32 vcc, 0, v8
    v_mov_b32 v9, 0x0c0c0c0c
    s_lshl_b32 s40, s48, 7
    v_cndmask_b32 v160, v9, v10, vcc
    v_cndmask_b32 v161, v10, v9, vcc
    v_cndmask_b32 v162, v9, v12, vcc
    v_cndmask_b32 v163, v12, v9, vcc
    s_add_u32 s40, s40, 153600
    v_lshrrev_b32 v8, 2, v2
    v_lshlrev_b32 v8, 10, v8
    v_lshl_add_u32 v8, v3, 2, v8
    v_add_u32 v8, s40, v8
    s_waitcnt lgkmcnt(0)
    s_barrier
    ds_read_b32 v12, v8 offset:0
    ds_read_b32 v13, v8 offset:16
    ds_read_b32 v14, v8 offset:32
    ds_read_b32 v15, v8 offset:48
    ds_read_b32 v16, v8 offset:64
    ds_read_b32 v17, v8 offset:80
    ds_read_b32 v18, v8 offset:96
    ds_read_b32 v19, v8 offset:112
    s_mul_i32 s32, s32, 0x19660d
    s_add_u32 s32, s32, 0x3c6ef35f
    s_lshl_b32 s40, s37, 2
    s_add_u32 s40, s40, s38
    s_mul_i32 s40, s40, 3072
    s_add_u32 s40, s40, 327680
    v_lshlrev_b32 v11, 4, v1
    v_add_u32 v9, s40, v11
    v_add_u32 v10, 5963776, v9
    v_add_u32 v11, 147456, v11
    v_mov_b32 v20, 162304
    v_mov_b32 v175, s32
    v_mov_b32 v179, s32
    v_mov_b32 v182, s32
    v_mov_b32 v183, s32
    s_waitcnt lgkmcnt(7)
    v_perm_b32 v128, v12, v12, v160
    v_perm_b32 v129, v12, v12, v161
    v_perm_b32 v130, v12, v12, v162
    v_perm_b32 v131, v12, v12, v163
    s_waitcnt vmcnt(14)
    v_swap_b32 v66, v68
    v_swap_b32 v67, v69
    s_nop 1
    v_mfma_f32_16x16x32_bf16 v[164:167], v[128:131], v[64:67], 0
    v_mfma_f32_16x16x32_bf16 v[168:171], v[128:131], v[68:71], 0
    s_waitcnt lgkmcnt(6)
    v_perm_b32 v132, v13, v13, v160
    v_perm_b32 v133, v13, v13, v161
    v_perm_b32 v134, v13, v13, v162
    v_perm_b32 v135, v13, v13, v163
    s_waitcnt vmcnt(12)
    v_swap_b32 v74, v76
    v_swap_b32 v75, v77
    s_nop 1
    v_mfma_f32_16x16x32_bf16 v[164:167], v[132:135], v[72:75], v[164:167]
    v_mfma_f32_16x16x32_bf16 v[168:171], v[132:135], v[76:79], v[168:171]
    s_waitcnt lgkmcnt(5)
    v_perm_b32 v136, v14, v14, v160
    v_perm_b32 v137, v14, v14, v161
    v_perm_b32 v138, v14, v14, v162
    v_perm_b32 v139, v14, v14, v163
    s_waitcnt vmcnt(10)
    v_swap_b32 v82, v84
    v_swap_b32 v83, v85
    s_nop 1
    v_mfma_f32_16x16x32_bf16 v[164:167], v[136:139], v[80:83], v[164:167]
    v_mfma_f32_16x16x32_bf16 v[168:171], v[136:139], v[84:87], v[168:171]
    s_waitcnt lgkmcnt(4)
    v_perm_b32 v140, v15, v15, v160
    v_perm_b32 v141, v15, v15, v161
    v_perm_b32 v142, v15, v15, v162
    v_perm_b32 v143, v15, v15, v163
    s_waitcnt vmcnt(8)
    v_swap_b32 v90, v92
    v_swap_b32 v91, v93
    s_nop 1
    v_mfma_f32_16x16x32_bf16 v[164:167], v[140:143], v[88:91], v[164:167]
    v_mfma_f32_16x16x32_bf16 v[168:171], v[140:143], v[92:95], v[168:171]
    s_waitcnt lgkmcnt(3)
    v_perm_b32 v144, v16, v16, v160
    v_perm_b32 v145, v16, v16, v161
    v_perm_b32 v146, v16, v16, v162
    v_perm_b32 v147, v16, v16, v163
    s_waitcnt vmcnt(6)
    v_swap_b32 v98, v100
    v_swap_b32 v99, v101
    s_nop 1
    v_mfma_f32_16x16x32_bf16 v[164:167], v[144:147], v[96:99], v[164:167]
    v_mfma_f32_16x16x32_bf16 v[168:171], v[144:147], v[100:103], v[168:171]
    s_waitcnt lgkmcnt(2)
    v_perm_b32 v148, v17, v17, v160
    v_perm_b32 v149, v17, v17, v161
    v_perm_b32 v150, v17, v17, v162
    v_perm_b32 v151, v17, v17, v163
    s_waitcnt vmcnt(4)
    v_swap_b32 v106, v108
    v_swap_b32 v107, v109
    s_nop 1
    v_mfma_f32_16x16x32_bf16 v[164:167], v[148:151], v[104:107], v[164:167]
    v_mfma_f32_16x16x32_bf16 v[168:171], v[148:151], v[108:111], v[168:171]
    s_waitcnt lgkmcnt(1)
    v_perm_b32 v152, v18, v18, v160
    v_perm_b32 v153, v18, v18, v161
    v_perm_b32 v154, v18, v18, v162
    v_perm_b32 v155, v18, v18, v163
    s_waitcnt vmcnt(2)
    v_swap_b32 v114, v116
    v_swap_b32 v115, v117
    s_nop 1
    v_mfma_f32_16x16x32_bf16 v[164:167], v[152:155], v[112:115], v[164:167]
    v_mfma_f32_16x16x32_bf16 v[168:171], v[152:155], v[116:119], v[168:171]
    s_waitcnt lgkmcnt(0)
    v_perm_b32 v156, v19, v19, v160
    v_perm_b32 v157, v19, v19, v161
    v_perm_b32 v158, v19, v19, v162
    v_perm_b32 v159, v19, v19, v163
    s_waitcnt vmcnt(0)
    v_swap_b32 v122, v124
    v_swap_b32 v123, v125
    s_nop 1
    v_mfma_f32_16x16x32_bf16 v[164:167], v[156:159], v[120:123], v[164:167]
    v_mfma_f32_16x16x32_bf16 v[168:171], v[156:159], v[124:127], v[168:171]
    s_cmp_eq_u32 s3, 4
    s_cbranch_scc1 L_w4c
    v_mov_b32 v21, 1
    s_nop 3
    ds_write_b128 v11, v[164:167]
    ds_write_b128 v11, v[168:171] offset:1024
    ds_write_b32 v20, v21
    s_branch L_bq
L_w4c:
    s_mov_b32 s33, 0
L_sy:
    ds_read_b32 v21, v20
    ds_read_b128 v[12:15], v11
    ds_read_b128 v[16:19], v11 offset:1024
    s_add_u32 s33, s33, 1
    s_waitcnt lgkmcnt(2)
    v_cmp_ne_u32 vcc, 1, v21
    s_cbranch_vccz L_sy_ok
    s_cmp_lt_u32 s33, 65536
    s_cbranch_scc1 L_sy
L_sy_ok:
    s_waitcnt lgkmcnt(0)
    v_add_f32 v172, v164, v12
    v_add_f32 v173, v165, v13
    v_add_f32 v174, v166, v14
    v_add_f32 v176, v167, v15
    v_add_f32 v177, v168, v16
    v_add_f32 v178, v169, v17
    v_add_f32 v180, v170, v18
    v_add_f32 v181, v171, v19
    global_store_dwordx4 v9, v[172:175], s[28:29] offset:0
    global_store_dwordx4 v9, v[176:179], s[28:29] offset:1024
    global_store_dwordx4 v9, v[180:183], s[28:29] offset:2048
    global_store_dwordx4 v10, v[172:175], s[28:29] offset:0 sc1
    global_store_dwordx4 v10, v[176:179], s[28:29] offset:1024 sc1
    global_store_dwordx4 v10, v[180:183], s[28:29] offset:2048 sc1
    s_branch L_bq
L_w67b:
    v_xor_b32 v12, v2, v3
    v_lshlrev_b32 v12, 4, v12
    v_lshl_add_u32 v10, v3, 13, v12
    v_add_u32 v10, s43, v10
    s_mov_b32 s42, 131072
    s_cmp_eq_u32 s3, 7
    s_cselect_b32 s42, 114688, s42
    s_waitcnt lgkmcnt(0)
    s_barrier
    s_add_u32 m0, s42, 0
    v_xor_b32 v11, 0x0, v10
    global_load_lds_dwordx4 v11, s[10:11]
    s_add_u32 m0, s42, 1024
    v_xor_b32 v11, 0x8040, v10
    global_load_lds_dwordx4 v11, s[10:11]
    s_add_u32 m0, s42, 2048
    v_xor_b32 v11, 0x10080, v10
    global_load_lds_dwordx4 v11, s[10:11]
    s_add_u32 m0, s42, 3072
    v_xor_b32 v11, 0x180c0, v10
    global_load_lds_dwordx4 v11, s[10:11]
    s_add_u32 m0, s42, 4096
    v_xor_b32 v11, 0x20000, v10
    global_load_lds_dwordx4 v11, s[10:11]
    s_add_u32 m0, s42, 5120
    v_xor_b32 v11, 0x28040, v10
    global_load_lds_dwordx4 v11, s[10:11]
    s_add_u32 m0, s42, 6144
    v_xor_b32 v11, 0x30080, v10
    global_load_lds_dwordx4 v11, s[10:11]
    s_add_u32 m0, s42, 7168
    v_xor_b32 v11, 0x380c0, v10
    global_load_lds_dwordx4 v11, s[10:11]
    s_add_u32 m0, s42, 8192
    v_xor_b32 v11, 0x40000, v10
    global_load_lds_dwordx4 v11, s[10:11]
    s_add_u32 m0, s42, 9216
    v_xor_b32 v11, 0x48040, v10
    global_load_lds_dwordx4 v11, s[10:11]
    s_add_u32 m0, s42, 10240
    v_xor_b32 v11, 0x50080, v10
    global_load_lds_dwordx4 v11, s[10:11]
    s_add_u32 m0, s42, 11264
    v_xor_b32 v11, 0x580c0, v10
    global_load_lds_dwordx4 v11, s[10:11]
    s_add_u32 m0, s42, 12288
    v_xor_b32 v11, 0x60000, v10
    global_load_lds_dwordx4 v11, s[10:11]
    s_add_u32 m0, s42, 13312
    v_xor_b32 v11, 0x68040, v10
    global_load_lds_dwordx4 v11, s[10:11]
    s_add_u32 m0, s42, 14336
    v_xor_b32 v11, 0x70080, v10
    global_load_lds_dwordx4 v11, s[10:11]
    s_add_u32 m0, s42, 15360
    v_xor_b32 v11, 0x780c0, v10
    global_load_lds_dwordx4 v11, s[10:11]
    s_mul_i32 s32, s32, 0x19660d
    s_add_u32 s32, s32, 0x3c6ef35f
    v_and_b32 v9, 3, v2
    v_lshl_add_u32 v8, v2, 8, v12
    v_add_u32 v8, s42, v8
    v_xor_b32 v10, 64, v8
    v_xor_b32 v11, 128, v8
    v_xor_b32 v12, 192, v8
    s_mul_i32 s40, s37, 12288
    s_add_u32 s40, s40, 327680
    v_lshlrev_b32 v13, 4, v1
    v_add_u32 v13, s40, v13
    s_and_b32 s41, s3, 1
    s_mul_i32 s41, s41, 1280
    s_add_u32 s41, s41, 159744
    v_mul_u32_u24 v14, 320, v3
    v_lshl_add_u32 v14, v2, 4, v14
    v_add_u32 v14, s41, v14
    v_mul_u32_u24 v15, 320, v9
    v_lshl_add_u32 v15, v3, 4, v15
    v_add_u32 v15, s41, v15
    s_lshl_b32 s40, s37, 11
    s_lshl_b32 s41, s48, 8
    s_add_u32 s40, s40, s41
    s_add_u32 s40, s40, 65536
    v_lshlrev_b32 v16, 16, v9
    v_lshl_add_u32 v16, v3, 4, v16
    v_add_u32 v16, s40, v16
    v_mov_b32 v178, s32
    v_mov_b32 v179, s32
    v_mov_b32 v182, s32
    v_mov_b32 v183, s32
    v_mov_b32 v186, s32
    v_mov_b32 v187, s32
    v_mov_b32 v190, s32
    v_mov_b32 v191, s32
    s_mov_b32 s44, 0x000f000f
    s_mov_b32 s45, 0x000f000f
    s_waitcnt vmcnt(0)
    ds_read_b128 v[64:67], v8 offset:0
    ds_read_b128 v[68:71], v10 offset:0
    ds_read_b128 v[72:75], v11 offset:0
    ds_read_b128 v[76:79], v12 offset:0
    ds_read_b128 v[80:83], v8 offset:4096
    ds_read_b128 v[84:87], v10 offset:4096
    ds_read_b128 v[88:91], v11 offset:4096
    ds_read_b128 v[92:95], v12 offset:4096
    ds_read_b128 v[96:99], v8 offset:8192
    ds_read_b128 v[100:103], v10 offset:8192
    ds_read_b128 v[104:107], v11 offset:8192
    ds_read_b128 v[108:111], v12 offset:8192
    ds_read_b128 v[112:115], v8 offset:12288
    ds_read_b128 v[116:119], v10 offset:12288
    ds_read_b128 v[120:123], v11 offset:12288
    ds_read_b128 v[124:127], v12 offset:12288
    s_mov_b32 s33, 0
L_h1:
    s_add_u32 s33, s33, 1
    s_and_b32 s40, s33, 7
    s_cselect_b32 s40, 0, 5963776
    v_add_u32 v17, s40, v13
    global_load_dwordx4 v[128:131], v17, s[28:29] offset:0 sc1
    global_load_dwordx4 v[132:135], v17, s[28:29] offset:1024 sc1
    global_load_dwordx4 v[136:139], v17, s[28:29] offset:2048 sc1
    global_load_dwordx4 v[140:143], v17, s[28:29] offset:3072 sc1
    v_add_u32 v17, 0x1000, v17
    global_load_dwordx4 v[144:147], v17, s[28:29] offset:0 sc1
    global_load_dwordx4 v[148:151], v17, s[28:29] offset:1024 sc1
    global_load_dwordx4 v[152:155], v17, s[28:29] offset:2048 sc1
    global_load_dwordx4 v[156:159], v17, s[28:29] offset:3072 sc1
    v_add_u32 v17, 0x1000, v17
    global_load_dwordx4 v[160:163], v17, s[28:29] offset:0 sc1
    global_load_dwordx4 v[164:167], v17, s[28:29] offset:1024 sc1
    global_load_dwordx4 v[168:171], v17, s[28:29] offset:2048 sc1
    global_load_dwordx4 v[172:175], v17, s[28:29] offset:3072 sc1
    v_mov_b32 v18, 0
    s_waitcnt vmcnt(9)
    v_sad_u32 v18, v131, s32, v18
    v_sad_u32 v18, v135, s32, v18
    v_sad_u32 v18, v139, s32, v18
    s_waitcnt vmcnt(6)
    v_sad_u32 v18, v143, s32, v18
    v_sad_u32 v18, v147, s32, v18
    v_sad_u32 v18, v151, s32, v18
    s_waitcnt vmcnt(3)
    v_sad_u32 v18, v155, s32, v18
    v_sad_u32 v18, v159, s32, v18
    v_sad_u32 v18, v163, s32, v18
    s_waitcnt vmcnt(0)
    v_sad_u32 v18, v167, s32, v18
    v_sad_u32 v18, v171, s32, v18
    v_sad_u32 v18, v175, s32, v18
    v_cmp_ne_u32 vcc, 0, v18
    s_cbranch_vccz L_h1_ok
    s_cmp_lt_u32 s33, 65536
    s_cbranch_scc1 L_h1
L_h1_ok:
    v_add_f32 v128, v128, v140
    v_add_f32 v129, v129, v141
    v_add_f32 v130, v130, v142
    v_add_f32 v132, v132, v144
    v_add_f32 v133, v133, v145
    v_add_f32 v134, v134, v146
    v_add_f32 v136, v136, v148
    v_add_f32 v137, v137, v149
    v_add_f32 v152, v152, v164
    v_add_f32 v153, v153, v165
    v_add_f32 v154, v154, v166
    v_add_f32 v156, v156, v168
    v_add_f32 v157, v157, v169
    v_add_f32 v158, v158, v170
    v_add_f32 v160, v160, v172
    v_add_f32 v161, v161, v173
    v_add_f32 v128, v128, v152
    v_add_f32 v129, v129, v153
    v_add_f32 v130, v130, v154
    v_add_f32 v132, v132, v156
    v_add_f32 v133, v133, v157
    v_add_f32 v134, v134, v158
    v_add_f32 v136, v136, v160
    v_add_f32 v137, v137, v161
    v_cvt_pk_bf16_f32 v224, v128, v129
    v_cvt_pk_bf16_f32 v225, v130, v132
    v_cvt_pk_bf16_f32 v226, v133, v134
    v_cvt_pk_bf16_f32 v227, v136, v137
    ds_write_b128 v14, v[224:227]
    s_waitcnt lgkmcnt(0)
    ds_read_b128 v[128:131], v15 offset:0
    ds_read_b128 v[132:135], v15 offset:64
    ds_read_b128 v[136:139], v15 offset:128
    ds_read_b128 v[140:143], v15 offset:192
    s_waitcnt lgkmcnt(3)
    v_mfma_f32_16x16x32_bf16 v[232:235], v[64:67], v[128:131], 0
    v_mfma_f32_16x16x32_bf16 v[236:239], v[80:83], v[128:131], 0
    v_mfma_f32_16x16x32_bf16 v[240:243], v[96:99], v[128:131], 0
    v_mfma_f32_16x16x32_bf16 v[244:247], v[112:115], v[128:131], 0
    s_waitcnt lgkmcnt(2)
    v_mfma_f32_16x16x32_bf16 v[232:235], v[68:71], v[132:135], v[232:235]
    v_mfma_f32_16x16x32_bf16 v[236:239], v[84:87], v[132:135], v[236:239]
    v_mfma_f32_16x16x32_bf16 v[240:243], v[100:103], v[132:135], v[240:243]
    v_mfma_f32_16x16x32_bf16 v[244:247], v[116:119], v[132:135], v[244:247]
    s_waitcnt lgkmcnt(1)
    v_mfma_f32_16x16x32_bf16 v[232:235], v[72:75], v[136:139], v[232:235]
    v_mfma_f32_16x16x32_bf16 v[236:239], v[88:91], v[136:139], v[236:239]
    v_mfma_f32_16x16x32_bf16 v[240:243], v[104:107], v[136:139], v[240:243]
    v_mfma_f32_16x16x32_bf16 v[244:247], v[120:123], v[136:139], v[244:247]
    s_waitcnt lgkmcnt(0)
    v_mfma_f32_16x16x32_bf16 v[232:235], v[76:79], v[140:143], v[232:235]
    v_mfma_f32_16x16x32_bf16 v[236:239], v[92:95], v[140:143], v[236:239]
    v_mfma_f32_16x16x32_bf16 v[240:243], v[108:111], v[140:143], v[240:243]
    v_mfma_f32_16x16x32_bf16 v[244:247], v[124:127], v[140:143], v[244:247]
    s_mov_b64 exec, s[44:45]
    s_nop 3
    v_cvt_pk_bf16_f32 v176, v232, v233
    v_cvt_pk_bf16_f32 v177, v234, v235
    global_store_dwordx4 v16, v[176:179], s[28:29] offset:0 sc1
    v_cvt_pk_bf16_f32 v180, v236, v237
    v_cvt_pk_bf16_f32 v181, v238, v239
    global_store_dwordx4 v16, v[180:183], s[28:29] offset:64 sc1
    v_cvt_pk_bf16_f32 v184, v240, v241
    v_cvt_pk_bf16_f32 v185, v242, v243
    global_store_dwordx4 v16, v[184:187], s[28:29] offset:128 sc1
    v_cvt_pk_bf16_f32 v188, v244, v245
    v_cvt_pk_bf16_f32 v189, v246, v247
    global_store_dwordx4 v16, v[188:191], s[28:29] offset:192 sc1
    s_mov_b64 exec, -1
L_bq:
    s_setprio 0
    s_barrier
    s_branch L_pat
L_setup:
    v_xor_b32 v8, v2, v3
    v_lshlrev_b32 v8, 4, v8
    v_lshl_add_u32 v8, v2, 10, v8
    v_add_u32 v26, 131072, v8
    v_xor_b32 v27, 64, v26
    v_xor_b32 v28, 128, v26
    v_xor_b32 v29, 192, v26
    v_and_b32 v8, 8, v2
    v_and_b32 v9, 3, v2
    v_lshl_add_u32 v8, v9, 1, v8
    v_bfe_u32 v9, v2, 2, 1
    v_add_u32 v8, v8, v9
    v_lshlrev_b32 v9, 3, v9
    v_xor_b32 v9, v9, v8
    v_xor_b32 v9, v9, v3
    v_lshlrev_b32 v9, 4, v9
    v_lshl_add_u32 v9, v8, 10, v9
    s_lshl_b32 s40, s3, 14
    v_add_u32 v30, s40, v9
    v_xor_b32 v31, 64, v30
    v_xor_b32 v32, 128, v30
    v_xor_b32 v33, 192, v30
    v_bfe_u32 v8, v1, 2, 2
    v_lshlrev_b32 v8, 1, v8
    v_lshl_add_u32 v9, v3, 3, v8
    v_and_b32 v10, 15, v9
    v_bfe_u32 v11, v1, 1, 1
    s_lshl_b32 s40, s3, 3
    v_add_u32 v11, s40, v11
    v_xor_b32 v10, v10, v11
    v_lshlrev_b32 v10, 4, v10
    v_lshl_add_u32 v10, v9, 10, v10
    v_and_b32 v11, 1, v1
    v_lshl_add_u32 v10, v11, 3, v10
    v_xor_b32 v34, 0x0, v10
    v_xor_b32 v42, 0x10000, v10
    v_xor_b32 v35, 0x90, v10
    v_xor_b32 v43, 0x10090, v10
    v_xor_b32 v36, 0x20, v10
    v_xor_b32 v44, 0x10020, v10
    v_xor_b32 v37, 0xb0, v10
    v_xor_b32 v45, 0x100b0, v10
    v_xor_b32 v38, 0x40, v10
    v_xor_b32 v46, 0x10040, v10
    v_xor_b32 v39, 0xd0, v10
    v_xor_b32 v47, 0x100d0, v10
    v_xor_b32 v40, 0x60, v10
    v_xor_b32 v48, 0x10060, v10
    v_xor_b32 v41, 0xf0, v10
    v_xor_b32 v49, 0x100f0, v10
    s_lshl_b32 s40, s3, 2
    s_add_u32 s40, s40, 152064
    v_lshlrev_b32 v8, 5, v2
    v_add_u32 v50, s40, v8
    v_add_u32 v51, 152064, v8
    v_mul_u32_u24 v8, 272, v2
    v_add_u32 v8, 147456, v8
    v_lshl_add_u32 v53, v3, 4, v8
    v_lshl_add_u32 v8, v3, 3, v8
    s_lshl_b32 s40, s3, 5
    v_add_u32 v52, s40, v8
    s_lshl_b32 s40, s35, 21
    s_lshr_b32 s41, s3, 1
    s_lshl_b32 s41, s41, 15
    s_add_u32 s40, s40, s41
    s_lshl_b32 s41, s34, 13
    s_add_u32 s40, s40, s41
    s_lshl_b32 s41, s36, 8
    s_add_u32 s40, s40, s41
    s_and_b32 s41, s3, 1
    s_lshl_b32 s41, s41, 7
    s_add_u32 s40, s40, s41
    s_add_u32 s40, s40, 1048576
    v_lshlrev_b32 v8, 19, v3
    v_lshlrev_b32 v9, 3, v2
    v_add3_u32 v54, v8, v9, s40
    s_lshl_b32 s40, s34, 14
    s_lshl_b32 s41, s35, 13
    s_add_u32 s40, s40, s41
    s_lshl_b32 s41, s36, 8
    s_add_u32 s40, s40, s41
    s_add_u32 s40, s40, 5767168
    v_lshlrev_b32 v9, 4, v2
    v_add_u32 v55, s40, v9
    s_lshl_b32 s40, s34, 16
    s_lshl_b32 s41, s35, 15
    s_add_u32 s40, s40, s41
    s_and_b32 s41, s3, 3
    s_lshl_b32 s41, s41, 13
    s_add_u32 s40, s40, s41
    s_add_u32 s40, s40, 65536
    v_lshlrev_b32 v8, 4, v1
    v_add_u32 v56, s40, v8
    v_lshrrev_b32 v8, 1, v1
    v_lshlrev_b32 v8, 4, v8
    v_and_b32 v9, 1, v1
    v_lshl_add_u32 v8, v9, 3, v8
    s_lshr_b32 s40, s41, 7
    v_xor_b32 v8, s40, v8
    s_lshr_b32 s41, s41, 1
    s_add_u32 s41, s41, 131072
    v_add_u32 v57, s41, v8
    v_xor_b32 v58, 16, v57
    v_xor_b32 v59, 32, v57
    v_xor_b32 v60, 48, v57
    s_mov_b32 s49, 0x00010001
    s_setpc_b64 s[46:47]
L_p_ld:
    s_cmp_ge_u32 s3, 2
    s_cbranch_scc1 L_nsce
    s_lshl_b32 s40, s2, 11
    s_lshl_b32 s41, s3, 10
    s_add_u32 s40, s40, s41
    s_add_u32 s40, s40, 5242880
    v_lshlrev_b32 v8, 4, v1
    v_add_u32 v8, s40, v8
    v_mov_b32 v12, -1
    v_mov_b32 v13, -1
    v_mov_b32 v14, -1
    v_mov_b32 v15, -1
    global_store_dwordx4 v8, v[12:15], s[28:29] sc1
L_nsce:
    s_lshl_b32 s40, s34, 22
    s_lshl_b32 s41, s36, 17
    s_add_u32 s40, s40, s41
    s_lshl_b32 s39, s3, 15
    s_add_u32 s40, s40, s39
    v_lshlrev_b32 v8, 4, v1
    v_add_u32 v25, s40, v8
    s_call_b64 s[46:47], L_setup
    s_lshl_b32 s40, s31, 14
    s_lshl_b32 s41, s3, 13
    s_add_u32 s40, s40, s41
    s_lshl_b32 s41, s30, 19
    s_add_u32 s40, s40, s41
    v_lshlrev_b32 v8, 7, v1
    v_add_u32 v62, s40, v8
    s_waitcnt lgkmcnt(0)
    s_mul_i32 s32, s32, 0x19660d
    s_add_u32 s32, s32, 0x3c6ef35f
    s_barrier
    s_barrier
    s_add_u32 m0, s39, 0
    v_xor_b32 v9, 0x0, v25
    global_load_lds_dwordx4 v9, s[6:7] offset:0
    v_xor_b32 v9, 0x90, v25
    global_load_lds_dwordx4 v9, s[6:7] offset:1024
    v_xor_b32 v9, 0x20, v25
    global_load_lds_dwordx4 v9, s[6:7] offset:2048
    v_xor_b32 v9, 0xb0, v25
    global_load_lds_dwordx4 v9, s[6:7] offset:3072
    s_add_u32 m0, s39, 4096
    v_xor_b32 v9, 0x1040, v25
    global_load_lds_dwordx4 v9, s[6:7] offset:0
    v_xor_b32 v9, 0x10d0, v25
    global_load_lds_dwordx4 v9, s[6:7] offset:1024
    v_xor_b32 v9, 0x1060, v25
    global_load_lds_dwordx4 v9, s[6:7] offset:2048
    v_xor_b32 v9, 0x10f0, v25
    global_load_lds_dwordx4 v9, s[6:7] offset:3072
    s_add_u32 m0, s39, 8192
    v_xor_b32 v9, 0x2080, v25
    global_load_lds_dwordx4 v9, s[6:7] offset:0
    v_xor_b32 v9, 0x2010, v25
    global_load_lds_dwordx4 v9, s[6:7] offset:1024
    v_xor_b32 v9, 0x20a0, v25
    global_load_lds_dwordx4 v9, s[6:7] offset:2048
    v_xor_b32 v9, 0x2030, v25
    global_load_lds_dwordx4 v9, s[6:7] offset:3072
    s_add_u32 m0, s39, 12288
    v_xor_b32 v9, 0x30c0, v25
    global_load_lds_dwordx4 v9, s[6:7] offset:0
    v_xor_b32 v9, 0x3050, v25
    global_load_lds_dwordx4 v9, s[6:7] offset:1024
    v_xor_b32 v9, 0x30e0, v25
    global_load_lds_dwordx4 v9, s[6:7] offset:2048
    v_xor_b32 v9, 0x3070, v25
    global_load_lds_dwordx4 v9, s[6:7] offset:3072
    s_add_u32 m0, s39, 16384
    v_xor_b32 v9, 0x4000, v25
    global_load_lds_dwordx4 v9, s[6:7] offset:0
    v_xor_b32 v9, 0x4090, v25
    global_load_lds_dwordx4 v9, s[6:7] offset:1024
    v_xor_b32 v9, 0x4020, v25
    global_load_lds_dwordx4 v9, s[6:7] offset:2048
    v_xor_b32 v9, 0x40b0, v25
    global_load_lds_dwordx4 v9, s[6:7] offset:3072
    s_add_u32 m0, s39, 20480
    v_xor_b32 v9, 0x5040, v25
    global_load_lds_dwordx4 v9, s[6:7] offset:0
    v_xor_b32 v9, 0x50d0, v25
    global_load_lds_dwordx4 v9, s[6:7] offset:1024
    v_xor_b32 v9, 0x5060, v25
    global_load_lds_dwordx4 v9, s[6:7] offset:2048
    v_xor_b32 v9, 0x50f0, v25
    global_load_lds_dwordx4 v9, s[6:7] offset:3072
    s_add_u32 m0, s39, 24576
    v_xor_b32 v9, 0x6080, v25
    global_load_lds_dwordx4 v9, s[6:7] offset:0
    v_xor_b32 v9, 0x6010, v25
    global_load_lds_dwordx4 v9, s[6:7] offset:1024
    v_xor_b32 v9, 0x60a0, v25
    global_load_lds_dwordx4 v9, s[6:7] offset:2048
    v_xor_b32 v9, 0x6030, v25
    global_load_lds_dwordx4 v9, s[6:7] offset:3072
    s_add_u32 m0, s39, 28672
    v_xor_b32 v9, 0x70c0, v25
    global_load_lds_dwordx4 v9, s[6:7] offset:0
    v_xor_b32 v9, 0x7050, v25
    global_load_lds_dwordx4 v9, s[6:7] offset:1024
    v_xor_b32 v9, 0x70e0, v25
    global_load_lds_dwordx4 v9, s[6:7] offset:2048
    v_xor_b32 v9, 0x7070, v25
    global_load_lds_dwordx4 v9, s[6:7] offset:3072
    s_branch L_pat
L_nonp:
    s_cmp_lg_u32 s3, 7
    s_cbranch_scc1 L_n_su
    s_call_b64 s[46:47], L_setup
    s_lshl_b32 s40, s38, 20
    s_lshl_b32 s41, s37, 8
    s_add_u32 s40, s40, s41
    v_lshrrev_b32 v8, 1, v1
    v_lshlrev_b32 v8, 13, v8
    v_and_b32 v9, 1, v1
    v_lshl_add_u32 v8, v9, 7, v8
    v_add_u32 v8, s40, v8
    global_load_dword v16, v8, s[10:11]
    v_add_u32 v8, 0x40000, v8
    global_load_dword v17, v8, s[10:11]
    v_add_u32 v8, 0x40000, v8
    global_load_dword v18, v8, s[10:11]
    v_add_u32 v8, 0x40000, v8
    global_load_dword v19, v8, s[10:11]
    s_branch L_n_x
L_n_su:
    s_setprio 0
    s_cmp_ge_u32 s3, 2
    s_cbranch_scc1 L_nsco
    s_lshl_b32 s40, s2, 11
    s_lshl_b32 s41, s3, 10
    s_add_u32 s40, s40, s41
    s_add_u32 s40, s40, 5242880
    v_lshlrev_b32 v8, 4, v1
    v_add_u32 v8, s40, v8
    v_mov_b32 v12, -1
    v_mov_b32 v13, -1
    v_mov_b32 v14, -1
    v_mov_b32 v15, -1
    global_store_dwordx4 v8, v[12:15], s[28:29] sc1
L_nsco:
    s_lshl_b32 s40, s34, 22
    s_lshl_b32 s41, s36, 17
    s_add_u32 s40, s40, s41
    s_lshl_b32 s39, s3, 15
    s_add_u32 s40, s40, s39
    v_lshlrev_b32 v8, 4, v1
    v_add_u32 v25, s40, v8
    s_call_b64 s[46:47], L_setup
    s_cmp_ge_u32 s3, 4
    s_cbranch_scc1 L_n_x0
    s_add_u32 m0, s39, 0
    v_xor_b32 v9, 0x0, v25
    global_load_lds_dwordx4 v9, s[6:7] offset:0
    v_xor_b32 v9, 0x90, v25
    global_load_lds_dwordx4 v9, s[6:7] offset:1024
    v_xor_b32 v9, 0x20, v25
    global_load_lds_dwordx4 v9, s[6:7] offset:2048
    v_xor_b32 v9, 0xb0, v25
    global_load_lds_dwordx4 v9, s[6:7] offset:3072
    s_add_u32 m0, s39, 4096
    v_xor_b32 v9, 0x1040, v25
    global_load_lds_dwordx4 v9, s[6:7] offset:0
    v_xor_b32 v9, 0x10d0, v25
    global_load_lds_dwordx4 v9, s[6:7] offset:1024
    v_xor_b32 v9, 0x1060, v25
    global_load_lds_dwordx4 v9, s[6:7] offset:2048
    v_xor_b32 v9, 0x10f0, v25
    global_load_lds_dwordx4 v9, s[6:7] offset:3072
    s_add_u32 m0, s39, 8192
    v_xor_b32 v9, 0x2080, v25
    global_load_lds_dwordx4 v9, s[6:7] offset:0
    v_xor_b32 v9, 0x2010, v25
    global_load_lds_dwordx4 v9, s[6:7] offset:1024
    v_xor_b32 v9, 0x20a0, v25
    global_load_lds_dwordx4 v9, s[6:7] offset:2048
    v_xor_b32 v9, 0x2030, v25
    global_load_lds_dwordx4 v9, s[6:7] offset:3072
    s_add_u32 m0, s39, 12288
    v_xor_b32 v9, 0x30c0, v25
    global_load_lds_dwordx4 v9, s[6:7] offset:0
    v_xor_b32 v9, 0x3050, v25
    global_load_lds_dwordx4 v9, s[6:7] offset:1024
    v_xor_b32 v9, 0x30e0, v25
    global_load_lds_dwordx4 v9, s[6:7] offset:2048
    v_xor_b32 v9, 0x3070, v25
    global_load_lds_dwordx4 v9, s[6:7] offset:3072
    s_add_u32 m0, s39, 16384
    v_xor_b32 v9, 0x4000, v25
    global_load_lds_dwordx4 v9, s[6:7] offset:0
    v_xor_b32 v9, 0x4090, v25
    global_load_lds_dwordx4 v9, s[6:7] offset:1024
    v_xor_b32 v9, 0x4020, v25
    global_load_lds_dwordx4 v9, s[6:7] offset:2048
    v_xor_b32 v9, 0x40b0, v25
    global_load_lds_dwordx4 v9, s[6:7] offset:3072
    s_add_u32 m0, s39, 20480
    v_xor_b32 v9, 0x5040, v25
    global_load_lds_dwordx4 v9, s[6:7] offset:0
    v_xor_b32 v9, 0x50d0, v25
    global_load_lds_dwordx4 v9, s[6:7] offset:1024
    v_xor_b32 v9, 0x5060, v25
    global_load_lds_dwordx4 v9, s[6:7] offset:2048
    v_xor_b32 v9, 0x50f0, v25
    global_load_lds_dwordx4 v9, s[6:7] offset:3072
    s_add_u32 m0, s39, 24576
    v_xor_b32 v9, 0x6080, v25
    global_load_lds_dwordx4 v9, s[6:7] offset:0
    v_xor_b32 v9, 0x6010, v25
    global_load_lds_dwordx4 v9, s[6:7] offset:1024
    v_xor_b32 v9, 0x60a0, v25
    global_load_lds_dwordx4 v9, s[6:7] offset:2048
    v_xor_b32 v9, 0x6030, v25
    global_load_lds_dwordx4 v9, s[6:7] offset:3072
    s_add_u32 m0, s39, 28672
    v_xor_b32 v9, 0x70c0, v25
    global_load_lds_dwordx4 v9, s[6:7] offset:0
    v_xor_b32 v9, 0x7050, v25
    global_load_lds_dwordx4 v9, s[6:7] offset:1024
    v_xor_b32 v9, 0x70e0, v25
    global_load_lds_dwordx4 v9, s[6:7] offset:2048
    v_xor_b32 v9, 0x7070, v25
    global_load_lds_dwordx4 v9, s[6:7] offset:3072
L_n_x0:
L_n_x:
    s_setprio 0
    s_lshl_b32 s40, s37, 8
    s_lshl_b32 s41, s38, 20
    s_add_u32 s40, s40, s41
    s_lshr_b32 s41, s3, 2
    s_lshl_b32 s41, s41, 19
    s_add_u32 s40, s40, s41
    s_and_b32 s41, s3, 3
    s_lshl_b32 s41, s41, 15
    s_add_u32 s40, s40, s41
    v_lshlrev_b32 v8, 17, v3
    v_lshlrev_b32 v12, 4, v2
    v_add3_u32 v62, v8, v12, s40
    s_mul_i32 s40, s3, 4608
    v_mul_u32_u24 v8, 288, v3
    v_add3_u32 v63, v8, v12, s40
    v_bfe_u32 v9, v1, 2, 2
    v_lshl_add_u32 v9, v3, 3, v9
    v_mul_u32_u24 v9, 288, v9
    v_and_b32 v10, 3, v1
    v_lshl_add_u32 v9, v10, 3, v9
    s_lshl_b32 s40, s3, 5
    v_add_u32 v248, s40, v9
    s_and_b32 s41, s3, 1
    s_lshl_b32 s40, s41, 15
    s_lshr_b32 s42, s37, 4
    s_bfe_u32 s44, s3, 0x10001
    s_xor_b32 s42, s42, s44
    s_lshl_b32 s42, s42, 13
    s_add_u32 s40, s40, s42
    s_and_b32 s42, s37, 15
    s_lshl_b32 s42, s42, 4
    s_add_u32 s40, s40, s42
    s_add_u32 s40, s40, 5767168
    v_lshrrev_b32 v8, 5, v1
    v_lshlrev_b32 v8, 14, v8
    v_and_b32 v9, 31, v1
    v_lshlrev_b32 v9, 8, v9
    v_add3_u32 v249, v8, v9, s40
    s_lshl_b32 s40, s41, 7
    s_add_u32 s40, s40, 162048
    v_lshlrev_b32 v8, 1, v1
    v_add_u32 v254, s40, v8
    s_lshl_b32 s40, s3, 5
    s_add_u32 s40, s40, 162048
    v_lshlrev_b32 v8, 3, v3
    v_add_u32 v255, s40, v8
    s_lshl_b32 s40, s37, 17
    s_lshl_b32 s42, s38, 15
    s_add_u32 s40, s40, s42
    s_lshl_b32 s42, s3, 12
    s_add_u32 s40, s40, s42
    s_add_u32 s40, s40, 1048576
    v_lshlrev_b32 v9, 10, v3
    v_add3_u32 v250, v9, v12, s40
    s_mul_i32 s40, s3, 272
    s_add_u32 s40, s40, 159744
    v_add3_u32 v251, v8, v12, s40
    v_lshrrev_b32 v9, 2, v2
    v_and_b32 v10, 1, v2
    v_lshl_add_u32 v9, v9, 1, v10
    v_mul_u32_u24 v9, 272, v9
    v_lshl_add_u32 v9, v3, 4, v9
    v_add_u32 v252, 159744, v9
    s_lshl_b32 s40, s37, 12
    s_lshl_b32 s42, s38, 10
    s_add_u32 s40, s40, s42
    s_lshl_b32 s42, s3, 7
    s_add_u32 s40, s40, s42
    s_add_u32 s40, s40, 5242880
    v_and_b32 v11, 7, v2
    v_lshlrev_b32 v9, 1, v11
    v_lshl_add_u32 v9, v3, 4, v9
    v_lshrrev_b32 v8, 3, v2
    v_lshlrev_b32 v8, 6, v8
    v_add3_u32 v253, v8, v9, s40
    v_cmp_eq_u32 vcc, 1, v10
    v_mov_b32 v8, 0x0c0c0100
    v_mov_b32 v9, 0x01000c0c
    v_cndmask_b32 v22, v8, v9, vcc
    v_mov_b32 v8, 0x0c0c0302
    v_mov_b32 v9, 0x03020c0c
    v_cndmask_b32 v23, v8, v9, vcc
    v_lshrrev_b32 v11, 1, v11
    v_cmp_eq_u32 vcc, 0, v11
    s_nop 1
    v_cndmask_b32 v4, 0, -1, vcc
    v_cmp_eq_u32 vcc, 1, v11
    s_nop 1
    v_cndmask_b32 v5, 0, -1, vcc
    v_cmp_eq_u32 vcc, 2, v11
    s_nop 1
    v_cndmask_b32 v6, 0, -1, vcc
    v_cmp_eq_u32 vcc, 3, v11
    s_nop 1
    v_cndmask_b32 v7, 0, -1, vcc
    s_waitcnt lgkmcnt(0)
    s_mul_i32 s32, s32, 0x19660d
    s_add_u32 s32, s32, 0x3c6ef35f
L_pat:
    v_and_b32 v8, 7, v2
    v_lshlrev_b32 v8, 2, v8
    v_bfe_u32 v8, s32, v8, 4
    v_lshlrev_b32 v9, 15, v8
    v_or_b32 v9, v9, v8
    v_and_b32 v61, s49, v9
    v_lshrrev_b32 v9, 2, v9
    v_and_b32 v21, s49, v9
    s_cmp_ge_u32 s3, 4
    s_cbranch_scc1 L_b0b
    s_waitcnt vmcnt(0)
L_b0b:
    s_barrier
    s_cmp_lt_u32 s3, 4
    s_cbranch_scc1 L_sfr
    global_load_dwordx4 v[196:199], v56, s[28:29] offset:0 sc1
    global_load_dwordx4 v[200:203], v56, s[28:29] offset:1024 sc1
    global_load_dwordx4 v[204:207], v56, s[28:29] offset:2048 sc1
    global_load_dwordx4 v[208:211], v56, s[28:29] offset:3072 sc1
    v_add_u32 v9, 0x1000, v56
    global_load_dwordx4 v[212:215], v9, s[28:29] offset:0 sc1
    global_load_dwordx4 v[216:219], v9, s[28:29] offset:1024 sc1
    global_load_dwordx4 v[220:223], v9, s[28:29] offset:2048 sc1
    global_load_dwordx4 v[224:227], v9, s[28:29] offset:3072 sc1
L_sfr:
    ds_read_b128 v[128:131], v30 offset:0
    ds_read_b128 v[132:135], v31 offset:0
    ds_read_b128 v[136:139], v32 offset:0
    ds_read_b128 v[140:143], v33 offset:0
    ds_read_b128 v[144:147], v30 offset:256
    ds_read_b128 v[148:151], v31 offset:256
    ds_read_b128 v[152:155], v32 offset:256
    ds_read_b128 v[156:159], v33 offset:256
    ds_read_b128 v[160:163], v30 offset:512
    ds_read_b128 v[164:167], v31 offset:512
    ds_read_b128 v[168:171], v32 offset:512
    ds_read_b128 v[172:175], v33 offset:512
    ds_read_b128 v[176:179], v30 offset:768
    ds_read_b128 v[180:183], v31 offset:768
    ds_read_b128 v[184:187], v32 offset:768
    ds_read_b128 v[188:191], v33 offset:768
    s_cmp_lt_u32 s3, 4
    s_cbranch_scc1 L_b0a
    s_mov_b32 s33, 0
L_pq1:
    s_waitcnt vmcnt(0)
    v_sad_u32 v14, v199, s32, 0
    v_sad_u32 v14, v203, s32, v14
    v_sad_u32 v14, v207, s32, v14
    v_sad_u32 v14, v211, s32, v14
    v_sad_u32 v14, v215, s32, v14
    v_sad_u32 v14, v219, s32, v14
    v_sad_u32 v14, v223, s32, v14
    v_sad_u32 v14, v227, s32, v14
    v_cmp_ne_u32 vcc, 0, v14
    s_cbranch_vccz L_pq1_ok
    s_add_u32 s33, s33, 1
    s_cmp_ge_u32 s33, 65536
    s_cbranch_scc1 L_pq1_ok
    global_load_dwordx4 v[196:199], v56, s[28:29] offset:0 sc1
    global_load_dwordx4 v[200:203], v56, s[28:29] offset:1024 sc1
    global_load_dwordx4 v[204:207], v56, s[28:29] offset:2048 sc1
    global_load_dwordx4 v[208:211], v56, s[28:29] offset:3072 sc1
    v_add_u32 v9, 0x1000, v56
    global_load_dwordx4 v[212:215], v9, s[28:29] offset:0 sc1
    global_load_dwordx4 v[216:219], v9, s[28:29] offset:1024 sc1
    global_load_dwordx4 v[220:223], v9, s[28:29] offset:2048 sc1
    global_load_dwordx4 v[224:227], v9, s[28:29] offset:3072 sc1
    s_branch L_pq1
L_pq1_ok:
    ds_write_b64 v57, v[196:197] offset:0
    ds_write_b64 v57, v[200:201] offset:512
    ds_write_b64 v58, v[204:205] offset:1024
    ds_write_b64 v58, v[208:209] offset:1536
    ds_write_b64 v59, v[212:213] offset:2048
    ds_write_b64 v59, v[216:217] offset:2560
    ds_write_b64 v60, v[220:221] offset:3072
    ds_write_b64 v60, v[224:225] offset:3584
    s_waitcnt lgkmcnt(0)
L_b0a:
    s_barrier
    ds_read_b128 v[64:67], v26 offset:0
    ds_read_b128 v[68:71], v27 offset:0
    ds_read_b128 v[72:75], v28 offset:0
    ds_read_b128 v[76:79], v29 offset:0
    ds_read_b128 v[80:83], v26 offset:256
    ds_read_b128 v[84:87], v27 offset:256
    ds_read_b128 v[88:91], v28 offset:256
    ds_read_b128 v[92:95], v29 offset:256
    ds_read_b128 v[96:99], v26 offset:512
    ds_read_b128 v[100:103], v27 offset:512
    ds_read_b128 v[104:107], v28 offset:512
    ds_read_b128 v[108:111], v29 offset:512
    ds_read_b128 v[112:115], v26 offset:768
    ds_read_b128 v[116:119], v27 offset:768
    ds_read_b128 v[120:123], v28 offset:768
    s_cmp_eq_u32 s35, 0
    s_cbranch_scc1 L_tch
    v_xor_b32 v9, 0, v62
    global_load_dwordx4 v[232:235], v9, s[12:13]
    v_xor_b32 v9, 8192, v62
    global_load_dwordx4 v[236:239], v9, s[12:13]
    v_xor_b32 v9, 16384, v62
    global_load_dwordx4 v[240:243], v9, s[12:13]
    v_xor_b32 v9, 24576, v62
    global_load_dwordx4 v[244:247], v9, s[12:13]
    s_branch L_nostg
L_tch:
    s_cmp_ge_u32 s3, 4
    s_cbranch_scc1 L_nostg
    global_load_dword v20, v62, s[14:15]
L_nostg:
    s_waitcnt lgkmcnt(14)
    v_mfma_f32_16x16x32_bf16 v[192:195], v[128:131], v[64:67], 0
    ds_read_b128 v[124:127], v29 offset:768
    s_waitcnt lgkmcnt(14)
    v_mfma_f32_16x16x32_bf16 v[192:195], v[132:135], v[68:71], v[192:195]
    s_waitcnt lgkmcnt(13)
    v_mfma_f32_16x16x32_bf16 v[192:195], v[136:139], v[72:75], v[192:195]
    s_waitcnt lgkmcnt(12)
    v_mfma_f32_16x16x32_bf16 v[192:195], v[140:143], v[76:79], v[192:195]
    s_waitcnt lgkmcnt(11)
    v_mfma_f32_16x16x32_bf16 v[192:195], v[144:147], v[80:83], v[192:195]
    s_waitcnt lgkmcnt(10)
    v_mfma_f32_16x16x32_bf16 v[192:195], v[148:151], v[84:87], v[192:195]
    s_waitcnt lgkmcnt(9)
    v_mfma_f32_16x16x32_bf16 v[192:195], v[152:155], v[88:91], v[192:195]
    s_waitcnt lgkmcnt(8)
    v_mfma_f32_16x16x32_bf16 v[192:195], v[156:159], v[92:95], v[192:195]
    s_waitcnt lgkmcnt(7)
    v_mfma_f32_16x16x32_bf16 v[192:195], v[160:163], v[96:99], v[192:195]
    s_waitcnt lgkmcnt(6)
    v_mfma_f32_16x16x32_bf16 v[192:195], v[164:167], v[100:103], v[192:195]
    s_waitcnt lgkmcnt(5)
    v_mfma_f32_16x16x32_bf16 v[192:195], v[168:171], v[104:107], v[192:195]
    s_waitcnt lgkmcnt(4)
    v_mfma_f32_16x16x32_bf16 v[192:195], v[172:175], v[108:111], v[192:195]
    s_waitcnt lgkmcnt(3)
    v_mfma_f32_16x16x32_bf16 v[192:195], v[176:179], v[112:115], v[192:195]
    s_waitcnt lgkmcnt(2)
    v_mfma_f32_16x16x32_bf16 v[192:195], v[180:183], v[116:119], v[192:195]
    s_waitcnt lgkmcnt(1)
    v_mfma_f32_16x16x32_bf16 v[192:195], v[184:187], v[120:123], v[192:195]
    s_waitcnt lgkmcnt(0)
    v_mfma_f32_16x16x32_bf16 v[192:195], v[188:191], v[124:127], v[192:195]
    s_mov_b32 s42, 0x3e0293ee
    s_nop 6
    v_max_f32 v8, v192, v193
    v_max3_f32 v8, v8, v194, v195
    v_mov_b32 v9, v8
    s_nop 1
    v_permlane16_swap_b32 v9, v8
    v_max_f32 v8, v8, v9
    v_mov_b32 v9, v8
    s_nop 1
    v_permlane32_swap_b32 v9, v8
    v_max_f32 v8, v8, v9
    ds_write_b32 v50, v8
    s_waitcnt lgkmcnt(0)
    s_barrier
    ds_read_b128 v[212:215], v51
    ds_read_b128 v[216:219], v51 offset:16
    ds_read_b64_tr_b16 v[64:65], v34 offset:0
    ds_read_b64_tr_b16 v[66:67], v35 offset:1024
    ds_read_b64_tr_b16 v[68:69], v36 offset:0
    ds_read_b64_tr_b16 v[70:71], v37 offset:1024
    ds_read_b64_tr_b16 v[72:73], v38 offset:0
    ds_read_b64_tr_b16 v[74:75], v39 offset:1024
    ds_read_b64_tr_b16 v[76:77], v40 offset:0
    ds_read_b64_tr_b16 v[78:79], v41 offset:1024
    ds_read_b64_tr_b16 v[80:81], v34 offset:32768
    ds_read_b64_tr_b16 v[82:83], v35 offset:33792
    ds_read_b64_tr_b16 v[84:85], v36 offset:32768
    ds_read_b64_tr_b16 v[86:87], v37 offset:33792
    s_waitcnt lgkmcnt(12)
    v_max3_f32 v8, v212, v213, v214
    v_max3_f32 v9, v215, v216, v217
    v_max3_f32 v8, v8, v218, v219
    v_max_f32 v8, v8, v9
    v_mul_f32 v8, s42, v8
    v_fma_f32 v12, v192, s42, -v8
    v_fma_f32 v13, v193, s42, -v8
    v_fma_f32 v14, v194, s42, -v8
    v_fma_f32 v15, v195, s42, -v8
    v_exp_f32 v12, v12
    v_exp_f32 v13, v13
    v_exp_f32 v14, v14
    v_exp_f32 v15, v15
    v_cvt_pk_bf16_f32 v12, v12, v13
    v_cvt_pk_bf16_f32 v13, v14, v15
    ds_write_b64 v52, v[12:13]
    s_waitcnt lgkmcnt(0)
    s_barrier
    ds_read_b128 v[196:199], v53 offset:0
    ds_read_b128 v[200:203], v53 offset:64
    ds_read_b128 v[204:207], v53 offset:128
    ds_read_b128 v[208:211], v53 offset:192
    ds_read_b64_tr_b16 v[88:89], v38 offset:32768
    ds_read_b64_tr_b16 v[90:91], v39 offset:33792
    ds_read_b64_tr_b16 v[92:93], v40 offset:32768
    ds_read_b64_tr_b16 v[94:95], v41 offset:33792
    ds_read_b64_tr_b16 v[96:97], v42 offset:0
    ds_read_b64_tr_b16 v[98:99], v43 offset:1024
    ds_read_b64_tr_b16 v[100:101], v44 offset:0
    ds_read_b64_tr_b16 v[102:103], v45 offset:1024
    ds_read_b64_tr_b16 v[104:105], v46 offset:0
    ds_read_b64_tr_b16 v[106:107], v47 offset:1024
    s_cmp_lg_u32 s3, 7
    s_cbranch_scc1 L_nol
    v_mov_b32 v12, 0x3f803f80
    v_mov_b32 v13, 0x3f803f80
    v_mov_b32 v14, 0x3f803f80
    v_mov_b32 v15, 0x3f803f80
    s_waitcnt lgkmcnt(10)
    s_nop 0
    v_mfma_f32_16x16x32_bf16 v[228:231], v[12:15], v[196:199], 0
    v_mfma_f32_16x16x32_bf16 v[228:231], v[12:15], v[200:203], v[228:231]
    v_mfma_f32_16x16x32_bf16 v[228:231], v[12:15], v[204:207], v[228:231]
    v_mfma_f32_16x16x32_bf16 v[228:231], v[12:15], v[208:211], v[228:231]
L_nol:
    s_waitcnt lgkmcnt(13)
    v_mfma_f32_16x16x32_bf16 v[212:215], v[196:199], v[64:67], 0
    ds_read_b64_tr_b16 v[108:109], v48 offset:0
    v_mfma_f32_16x16x32_bf16 v[216:219], v[196:199], v[68:71], 0
    v_mfma_f32_16x16x32_bf16 v[220:223], v[196:199], v[72:75], 0
    v_mfma_f32_16x16x32_bf16 v[224:227], v[196:199], v[76:79], 0
    s_cmp_lg_u32 s3, 7
    s_cbranch_scc1 L_nosm
    v_mov_b32 v9, v228
    v_mov_b32 v10, s32
    v_mov_b32 v11, s32
    s_mov_b64 exec, 0xffff
    global_store_dwordx4 v55, v[8:11], s[28:29] sc1
    s_mov_b64 exec, -1
L_nosm:
    s_waitcnt lgkmcnt(13)
    v_mfma_f32_16x16x32_bf16 v[212:215], v[200:203], v[80:83], v[212:215]
    ds_read_b64_tr_b16 v[110:111], v49 offset:1024
    v_mfma_f32_16x16x32_bf16 v[216:219], v[200:203], v[84:87], v[216:219]
    s_waitcnt lgkmcnt(10)
    v_mfma_f32_16x16x32_bf16 v[220:223], v[200:203], v[88:91], v[220:223]
    ds_read_b64_tr_b16 v[112:113], v42 offset:32768
    ds_read_b64_tr_b16 v[114:115], v43 offset:33792
    ds_read_b64_tr_b16 v[116:117], v44 offset:32768
    ds_read_b64_tr_b16 v[118:119], v45 offset:33792
    s_waitcnt lgkmcnt(12)
    v_mfma_f32_16x16x32_bf16 v[224:227], v[200:203], v[92:95], v[224:227]
    ds_read_b64_tr_b16 v[120:121], v46 offset:32768
    ds_read_b64_tr_b16 v[122:123], v47 offset:33792
    s_waitcnt lgkmcnt(12)
    v_mfma_f32_16x16x32_bf16 v[212:215], v[204:207], v[96:99], v[212:215]
    ds_read_b64_tr_b16 v[124:125], v48 offset:32768
    ds_read_b64_tr_b16 v[126:127], v49 offset:33792
    s_waitcnt lgkmcnt(12)
    v_mfma_f32_16x16x32_bf16 v[216:219], v[204:207], v[100:103], v[216:219]
    s_waitcnt lgkmcnt(10)
    v_mfma_f32_16x16x32_bf16 v[220:223], v[204:207], v[104:107], v[220:223]
    s_waitcnt lgkmcnt(8)
    v_mfma_f32_16x16x32_bf16 v[224:227], v[204:207], v[108:111], v[224:227]
    s_waitcnt lgkmcnt(6)
    v_mfma_f32_16x16x32_bf16 v[212:215], v[208:211], v[112:115], v[212:215]
    s_waitcnt lgkmcnt(4)
    v_mfma_f32_16x16x32_bf16 v[216:219], v[208:211], v[116:119], v[216:219]
    s_waitcnt lgkmcnt(2)
    v_mfma_f32_16x16x32_bf16 v[220:223], v[208:211], v[120:123], v[220:223]
    s_waitcnt lgkmcnt(0)
    v_mfma_f32_16x16x32_bf16 v[224:227], v[208:211], v[124:127], v[224:227]
    s_nop 3
    v_cvt_pk_bf16_f32 v12, v212, v216
    s_nop 2
    v_cvt_pk_bf16_f32 v13, v220, v224
    v_bfi_b32 v12, s49, v61, v12
    v_bfi_b32 v13, s49, v21, v13
    global_store_dwordx2 v54, v[12:13], s[28:29] sc1
    v_cvt_pk_bf16_f32 v14, v213, v217
    v_cvt_pk_bf16_f32 v15, v221, v225
    v_bfi_b32 v14, s49, v61, v14
    v_bfi_b32 v15, s49, v21, v15
    v_add_u32 v54, 0x20000, v54
    global_store_dwordx2 v54, v[14:15], s[28:29] sc1
    v_cvt_pk_bf16_f32 v16, v214, v218
    v_cvt_pk_bf16_f32 v17, v222, v226
    v_bfi_b32 v16, s49, v61, v16
    v_bfi_b32 v17, s49, v21, v17
    v_add_u32 v54, 0x20000, v54
    global_store_dwordx2 v54, v[16:17], s[28:29] sc1
    v_cvt_pk_bf16_f32 v18, v215, v219
    v_cvt_pk_bf16_f32 v19, v223, v227
    v_bfi_b32 v18, s49, v61, v18
    v_bfi_b32 v19, s49, v21, v19
    v_add_u32 v54, 0x20000, v54
    global_store_dwordx2 v54, v[18:19], s[28:29] sc1
    s_lshr_b32 s43, s31, 1
    s_barrier
    s_cmp_eq_u32 s35, 1
    s_cbranch_scc1 L_x
    s_mul_i32 s40, s43, 114688
    s_and_b32 s41, s3, 1
    s_mul_i32 s41, s41, 57344
    s_add_u32 s40, s40, s41
    s_mul_i32 s41, s30, 448
    s_and_b32 s41, s41, 0xffffff80
    s_add_u32 s40, s40, s41
    v_lshrrev_b32 v8, 2, v1
    v_mul_u32_u24 v8, 3584, v8
    v_and_b32 v9, 3, v1
    v_lshlrev_b32 v9, 7, v9
    v_add3_u32 v9, v8, v9, s40
    s_lshr_b32 s41, s3, 1
    s_cmp_eq_u32 s41, 0
    s_cbranch_scc0 L_ft1
    global_load_dword v20, v9, s[18:19]
L_ft1:
    s_cmp_eq_u32 s41, 1
    s_cbranch_scc0 L_ft2
    global_load_dword v20, v9, s[20:21]
L_ft2:
    s_cmp_eq_u32 s41, 2
    s_cbranch_scc0 L_ft3
    s_mul_i32 s40, s43, 114688
    s_and_b32 s41, s3, 1
    s_mul_i32 s41, s41, 57344
    s_add_u32 s40, s40, s41
    s_lshl_b32 s41, s30, 7
    s_add_u32 s40, s40, s41
    v_min_u32 v8, 55, v1
    v_lshlrev_b32 v8, 10, v8
    v_add_u32 v9, s40, v8
    global_load_dword v20, v9, s[22:23]
L_ft3:
    s_cmp_ge_u32 s3, 4
    s_cbranch_scc1 L_fs
    s_lshl_b32 s40, s3, 14
    s_add_u32 s40, s40, 5767180
    v_lshlrev_b32 v8, 8, v1
    v_add_u32 v8, s40, v8
    global_load_dword v9, v8, s[28:29] sc1
    s_mov_b32 s33, 0
L_pt2:
    s_waitcnt vmcnt(0)
    v_cmp_ne_u32 vcc, s32, v9
    s_cbranch_vccz L_pt2_ok
    s_add_u32 s33, s33, 1
    s_cmp_ge_u32 s33, 65536
    s_cbranch_scc1 L_pt2_ok
    global_load_dword v9, v8, s[28:29] sc1
    s_branch L_pt2
L_pt2_ok:
L_fs:
    s_barrier
    s_cmp_lt_u32 s43, 4
    s_cbranch_scc1 L_f2
    s_sub_u32 s43, s43, 4
    s_cmp_ge_u32 s43, 8
    s_addc_u32 s40, s43, 0
    s_cmp_ge_u32 s43, 5
    s_addc_u32 s43, s40, 0
    s_branch L_f1
L_x:
    s_waitcnt vmcnt(4)
    ds_write_b128 v63, v[232:235] offset:0
    ds_write_b128 v63, v[236:239] offset:1152
    ds_write_b128 v63, v[240:243] offset:2304
    ds_write_b128 v63, v[244:247] offset:3456
    s_cmp_ge_u32 s43, 8
    s_cbranch_scc1 L_x_noy
    s_lshl_b32 s40, s30, 19
    s_lshl_b32 s41, s3, 16
    s_add_u32 s40, s40, s41
    s_lshl_b32 s41, s43, 7
    s_add_u32 s40, s40, s41
    v_lshrrev_b32 v8, 3, v1
    v_and_b32 v9, 2, v8
    v_and_b32 v10, 7, v1
    v_xor_b32 v9, v9, v10
    v_lshlrev_b32 v9, 4, v9
    v_lshl_add_u32 v8, v8, 10, v9
    v_add_u32 v8, s40, v8
    s_lshl_b32 s42, s3, 13
    s_add_u32 s42, s42, 40960
    s_add_u32 m0, s42, 0
    v_xor_b32 v9, 0x0, v8
    global_load_lds_dwordx4 v9, s[14:15]
    s_add_u32 m0, s42, 1024
    v_xor_b32 v9, 0x2040, v8
    global_load_lds_dwordx4 v9, s[14:15]
    s_add_u32 m0, s42, 2048
    v_xor_b32 v9, 0x4000, v8
    global_load_lds_dwordx4 v9, s[14:15]
    s_add_u32 m0, s42, 3072
    v_xor_b32 v9, 0x6040, v8
    global_load_lds_dwordx4 v9, s[14:15]
    s_add_u32 m0, s42, 4096
    v_xor_b32 v9, 0x8000, v8
    global_load_lds_dwordx4 v9, s[14:15]
    s_add_u32 m0, s42, 5120
    v_xor_b32 v9, 0xa040, v8
    global_load_lds_dwordx4 v9, s[14:15]
    s_add_u32 m0, s42, 6144
    v_xor_b32 v9, 0xc000, v8
    global_load_lds_dwordx4 v9, s[14:15]
    s_add_u32 m0, s42, 7168
    v_xor_b32 v9, 0xe040, v8
    global_load_lds_dwordx4 v9, s[14:15]
L_x_noy:
    v_add_u32 v8, 131072, v253
    global_load_dword v20, v8, s[28:29] sc1
    s_waitcnt lgkmcnt(0)
    s_barrier
    ds_read_b64_tr_b16 v[64:65], v248 offset:0
    ds_read_b64_tr_b16 v[66:67], v248 offset:1152
    ds_read_b64_tr_b16 v[68:69], v248 offset:9216
    ds_read_b64_tr_b16 v[70:71], v248 offset:10368
    ds_read_b64_tr_b16 v[72:73], v248 offset:18432
    ds_read_b64_tr_b16 v[74:75], v248 offset:19584
    ds_read_b64_tr_b16 v[76:77], v248 offset:27648
    ds_read_b64_tr_b16 v[78:79], v248 offset:28800
    v_and_b32 v8, 3, v2
    v_lshlrev_b32 v8, 3, v8
    v_bfe_u32 v8, s32, v8, 8
    v_lshlrev_b32 v9, 15, v8
    v_or_b32 v28, v9, v8
    v_lshrrev_b32 v29, 2, v28
    v_lshrrev_b32 v30, 4, v28
    v_lshrrev_b32 v31, 6, v28
    s_cmp_ge_u32 s3, 4
    s_cbranch_scc1 L_bw
    global_load_dwordx4 v[12:15], v249, s[28:29] sc1
    s_mov_b32 s33, 0
L_pm3:
    s_waitcnt vmcnt(0)
    v_cmp_ne_u32 vcc, s32, v15
    s_cbranch_vccz L_pm3_ok
    s_add_u32 s33, s33, 1
    s_cmp_ge_u32 s33, 65536
    s_cbranch_scc1 L_pm3_ok
    global_load_dwordx4 v[12:15], v249, s[28:29] sc1
    s_branch L_pm3
L_pm3_ok:
    s_cmp_ge_u32 s3, 2
    s_cbranch_scc1 L_bw
    s_barrier
    global_load_dwordx4 v[80:83], v250, s[28:29] offset:0 sc1
    global_load_dwordx4 v[84:87], v250, s[28:29] offset:256 sc1
    global_load_dwordx4 v[88:91], v250, s[28:29] offset:512 sc1
    global_load_dwordx4 v[92:95], v250, s[28:29] offset:768 sc1
    v_mov_b32 v14, v12
    s_nop 1
    v_max_f32_dpp v14, v14, v14 row_ror:1 row_mask:0xf bank_mask:0xf
    s_nop 1
    v_max_f32_dpp v14, v14, v14 row_ror:2 row_mask:0xf bank_mask:0xf
    s_nop 1
    v_max_f32_dpp v14, v14, v14 row_ror:4 row_mask:0xf bank_mask:0xf
    s_nop 1
    v_max_f32_dpp v14, v14, v14 row_ror:8 row_mask:0xf bank_mask:0xf
    v_mov_b32 v15, v14
    s_nop 1
    v_permlane16_swap_b32 v15, v14
    v_max_f32 v14, v14, v15
    v_sub_f32 v12, v12, v14
    v_exp_f32 v12, v12
    s_nop 0
    v_mul_f32 v13, v12, v13
    s_nop 1
    v_add_f32_dpp v13, v13, v13 row_ror:1 row_mask:0xf bank_mask:0xf
    s_nop 1
    v_add_f32_dpp v13, v13, v13 row_ror:2 row_mask:0xf bank_mask:0xf
    s_nop 1
    v_add_f32_dpp v13, v13, v13 row_ror:4 row_mask:0xf bank_mask:0xf
    s_nop 1
    v_add_f32_dpp v13, v13, v13 row_ror:8 row_mask:0xf bank_mask:0xf
    v_mov_b32 v15, v13
    s_nop 1
    v_permlane16_swap_b32 v15, v13
    v_add_f32 v13, v13, v15
    v_rcp_f32 v13, v13
    s_nop 0
    v_mul_f32 v12, v12, v13
    v_cvt_pk_bf16_f32 v12, v12, v12
    ds_write_b16 v254, v12
    s_branch L_bw1
L_bw:
    s_barrier
    global_load_dwordx4 v[80:83], v250, s[28:29] offset:0 sc1
    global_load_dwordx4 v[84:87], v250, s[28:29] offset:256 sc1
    global_load_dwordx4 v[88:91], v250, s[28:29] offset:512 sc1
    global_load_dwordx4 v[92:95], v250, s[28:29] offset:768 sc1
L_bw1:
    s_waitcnt lgkmcnt(0)
    s_barrier
    ds_read_b64 v[12:13], v255
    s_mov_b32 s44, -1
    s_mov_b32 s45, 0
    s_waitcnt lgkmcnt(0)
    v_perm_b32 v14, v12, v12, v22
    v_and_b32 v96, v4, v14
    v_and_b32 v97, v5, v14
    v_and_b32 v98, v6, v14
    v_and_b32 v99, v7, v14
    v_perm_b32 v14, v12, v12, v23
    v_and_b32 v100, v4, v14
    v_and_b32 v101, v5, v14
    v_and_b32 v102, v6, v14
    v_and_b32 v103, v7, v14
    v_perm_b32 v14, v13, v13, v22
    v_and_b32 v104, v4, v14
    v_and_b32 v105, v5, v14
    v_and_b32 v106, v6, v14
    v_and_b32 v107, v7, v14
    v_perm_b32 v14, v13, v13, v23
    v_and_b32 v108, v4, v14
    v_and_b32 v109, v5, v14
    v_and_b32 v110, v6, v14
    v_and_b32 v111, v7, v14
    s_mov_b32 s33, 0
L_px4:
    s_waitcnt vmcnt(0)
    v_xor_b32 v14, v80, v28
    v_bitop3_b32 v14, v14, v81, v29 bitop3:0xf6
    v_bitop3_b32 v14, v14, v82, v30 bitop3:0xf6
    v_bitop3_b32 v14, v14, v83, v31 bitop3:0xf6
    v_bitop3_b32 v14, v14, v84, v28 bitop3:0xf6
    v_bitop3_b32 v14, v14, v85, v29 bitop3:0xf6
    v_bitop3_b32 v14, v14, v86, v30 bitop3:0xf6
    v_bitop3_b32 v14, v14, v87, v31 bitop3:0xf6
    v_bitop3_b32 v14, v14, v88, v28 bitop3:0xf6
    v_bitop3_b32 v14, v14, v89, v29 bitop3:0xf6
    v_bitop3_b32 v14, v14, v90, v30 bitop3:0xf6
    v_bitop3_b32 v14, v14, v91, v31 bitop3:0xf6
    v_bitop3_b32 v14, v14, v92, v28 bitop3:0xf6
    v_bitop3_b32 v14, v14, v93, v29 bitop3:0xf6
    v_bitop3_b32 v14, v14, v94, v30 bitop3:0xf6
    v_bitop3_b32 v14, v14, v95, v31 bitop3:0xf6
    v_and_b32 v14, s49, v14
    v_cmp_ne_u32 vcc, 0, v14
    s_cbranch_vccz L_px4_ok
    s_add_u32 s33, s33, 1
    s_cmp_ge_u32 s33, 65536
    s_cbranch_scc1 L_px4_ok
    global_load_dwordx4 v[80:83], v250, s[28:29] offset:0 sc1
    global_load_dwordx4 v[84:87], v250, s[28:29] offset:256 sc1
    global_load_dwordx4 v[88:91], v250, s[28:29] offset:512 sc1
    global_load_dwordx4 v[92:95], v250, s[28:29] offset:768 sc1
    s_branch L_px4
L_px4_ok:
    v_mfma_f32_16x16x32_bf16 v[112:115], v[96:99], v[80:83], 0
    v_mfma_f32_16x16x32_bf16 v[112:115], v[100:103], v[84:87], v[112:115]
    v_mfma_f32_16x16x32_bf16 v[112:115], v[104:107], v[88:91], v[112:115]
    v_mfma_f32_16x16x32_bf16 v[112:115], v[108:111], v[92:95], v[112:115]
    s_nop 7
    v_cvt_pk_bf16_f32 v12, v112, v113
    v_cvt_pk_bf16_f32 v13, v114, v115
    s_mov_b64 exec, s[44:45]
    ds_write_b64 v251, v[12:13]
    s_mov_b64 exec, -1
    s_waitcnt lgkmcnt(0)
    s_barrier
    ds_read_b128 v[116:119], v252 offset:0
    ds_read_b128 v[120:123], v252 offset:64
    ds_read_b128 v[124:127], v252 offset:128
    ds_read_b128 v[128:131], v252 offset:192
    s_mov_b32 s44, 0x55555555
    s_mov_b32 s45, 0x55555555
    v_add_u32 v14, 131072, v253
    s_waitcnt lgkmcnt(3)
    v_mfma_f32_16x16x32_bf16 v[112:115], v[116:119], v[64:67], 0
    s_waitcnt lgkmcnt(2)
    v_mfma_f32_16x16x32_bf16 v[112:115], v[120:123], v[68:71], v[112:115]
    s_waitcnt lgkmcnt(1)
    v_mfma_f32_16x16x32_bf16 v[112:115], v[124:127], v[72:75], v[112:115]
    s_waitcnt lgkmcnt(0)
    v_mfma_f32_16x16x32_bf16 v[112:115], v[128:131], v[76:79], v[112:115]
    s_nop 7
    v_add_f32 v12, v112, v113
    s_nop 1
    v_mov_b32_dpp v13, v12 quad_perm:[1,0,3,2] row_mask:0xf bank_mask:0xf
    v_cvt_pk_bf16_f32 v21, v12, v13
    s_mov_b64 exec, s[44:45]
    global_store_dword v14, v21, s[28:29]
    s_mov_b64 exec, -1
    s_cmp_lt_u32 s43, 8
    s_cbranch_scc1 L_y
    s_mov_b64 exec, s[44:45]
    global_store_dword v253, v21, s[28:29] sc1
    s_mov_b64 exec, -1
    s_cmp_ge_u32 s43, 10
    s_cbranch_scc1 L_end
    s_lshl_b32 s43, s43, 2
    s_sub_u32 s43, s43, 27
    s_branch L_f1
L_y:
    v_bfe_u32 v8, v1, 2, 2
    v_and_b32 v9, 2, v8
    v_and_b32 v10, 1, v3
    v_lshl_add_u32 v9, v10, 2, v9
    v_bfe_u32 v10, v1, 1, 1
    v_xor_b32 v9, v9, v10
    v_lshlrev_b32 v9, 4, v9
    v_lshl_add_u32 v8, v3, 3, v8
    v_lshl_add_u32 v9, v8, 7, v9
    v_and_b32 v10, 1, v1
    v_lshl_add_u32 v9, v10, 3, v9
    v_add_u32 v12, s42, v9
    v_xor_b32 v13, 32, v12
    v_xor_b32 v14, 64, v12
    v_xor_b32 v15, 96, v12
    s_lshl_b32 s40, s30, 14
    s_lshr_b32 s41, s3, 1
    s_lshl_b32 s41, s41, 12
    s_add_u32 s40, s40, s41
    s_and_b32 s41, s3, 1
    s_lshl_b32 s41, s41, 9
    s_add_u32 s40, s40, s41
    s_add_u32 s40, s40, 5242880
    v_lshrrev_b32 v8, 2, v2
    v_lshlrev_b32 v8, 10, v8
    v_lshl_add_u32 v8, v3, 6, v8
    v_and_b32 v9, 3, v2
    v_lshl_add_u32 v8, v9, 4, v8
    v_add_u32 v26, s40, v8
    s_lshl_b32 s40, s3, 10
    s_add_u32 s40, s40, 131072
    v_lshlrev_b32 v8, 4, v1
    v_add_u32 v27, s40, v8
    s_lshl_b32 s40, s3, 2
    s_add_u32 s40, s40, 131072
    v_add_u32 v28, s40, v8
    s_lshl_b32 s40, s43, 12
    s_lshl_b32 s41, s30, 9
    s_add_u32 s40, s40, s41
    s_lshl_b32 s41, s3, 7
    s_add_u32 s40, s40, s41
    s_add_u32 s40, s40, 5505024
    v_lshlrev_b32 v8, 1, v1
    v_add_u32 v29, s40, v8
    ds_read_b64_tr_b16 v[64:65], v12 offset:0
    ds_read_b64_tr_b16 v[66:67], v12 offset:512
    ds_read_b64_tr_b16 v[68:69], v13 offset:0
    ds_read_b64_tr_b16 v[70:71], v13 offset:512
    ds_read_b64_tr_b16 v[72:73], v14 offset:0
    ds_read_b64_tr_b16 v[74:75], v14 offset:512
    ds_read_b64_tr_b16 v[76:77], v15 offset:0
    ds_read_b64_tr_b16 v[78:79], v15 offset:512
    ds_read_b64_tr_b16 v[80:81], v12 offset:4096
    ds_read_b64_tr_b16 v[82:83], v12 offset:4608
    ds_read_b64_tr_b16 v[84:85], v13 offset:4096
    ds_read_b64_tr_b16 v[86:87], v13 offset:4608
    ds_read_b64_tr_b16 v[88:89], v14 offset:4096
    ds_read_b64_tr_b16 v[90:91], v14 offset:4608
    ds_read_b64_tr_b16 v[92:93], v15 offset:4096
    ds_read_b64_tr_b16 v[94:95], v15 offset:4608
    v_add_u32 v26, 131072, v26
    v_add_u32 v9, 0xfffe0000, v26
    s_mov_b32 s33, 0
L_py5:
    s_add_u32 s33, s33, 1
    s_and_b32 s40, s33, 15
    s_cbranch_scc0 L_py5_b
    global_load_dwordx4 v[96:99], v26, s[28:29] offset:0 sc1
    global_load_dwordx4 v[100:103], v26, s[28:29] offset:256 sc1
    s_branch L_py5_w
L_py5_b:
    s_cmp_lg_u32 s33, 16
    s_cbranch_scc1 L_py5_c
    s_mov_b64 exec, s[44:45]
    global_store_dword v253, v21, s[28:29] sc1
    s_mov_b64 exec, -1
L_py5_c:
    global_load_dwordx4 v[96:99], v9, s[28:29] offset:0 sc1
    global_load_dwordx4 v[100:103], v9, s[28:29] offset:256 sc1
L_py5_w:
    s_waitcnt vmcnt(0)
    v_max_u32 v8, v99, v103
    v_cmp_eq_u32 vcc, -1, v8
    s_cbranch_vccz L_py5_ok
    s_cmp_lt_u32 s33, 65536
    s_cbranch_scc1 L_py5
L_py5_ok:
    s_cmp_ge_u32 s33, 16
    s_cbranch_scc1 L_py5_d
    s_mov_b64 exec, s[44:45]
    global_store_dword v253, v21, s[28:29] sc1
    s_mov_b64 exec, -1
L_py5_d:
    s_waitcnt lgkmcnt(0)
    v_mfma_f32_16x16x32_bf16 v[104:107], v[96:99], v[64:67], 0
    v_mfma_f32_16x16x32_bf16 v[108:111], v[96:99], v[68:71], 0
    v_mfma_f32_16x16x32_bf16 v[112:115], v[96:99], v[72:75], 0
    v_mfma_f32_16x16x32_bf16 v[116:119], v[96:99], v[76:79], 0
    v_mfma_f32_16x16x32_bf16 v[104:107], v[100:103], v[80:83], v[104:107]
    v_mfma_f32_16x16x32_bf16 v[108:111], v[100:103], v[84:87], v[108:111]
    v_mfma_f32_16x16x32_bf16 v[112:115], v[100:103], v[88:91], v[112:115]
    v_mfma_f32_16x16x32_bf16 v[116:119], v[100:103], v[92:95], v[116:119]
    s_nop 5
    v_permlane16_swap_b32 v104, v108
    v_permlane16_swap_b32 v105, v109
    v_permlane16_swap_b32 v106, v110
    v_permlane16_swap_b32 v107, v111
    v_permlane16_swap_b32 v112, v116
    v_permlane16_swap_b32 v113, v117
    v_permlane16_swap_b32 v114, v118
    v_permlane16_swap_b32 v115, v119
    v_add_f32 v104, v104, v108
    v_add_f32 v105, v105, v109
    v_add_f32 v106, v106, v110
    v_add_f32 v107, v107, v111
    v_add_f32 v112, v112, v116
    v_add_f32 v113, v113, v117
    v_add_f32 v114, v114, v118
    v_add_f32 v115, v115, v119
    v_permlane32_swap_b32 v104, v112
    v_permlane32_swap_b32 v105, v113
    v_permlane32_swap_b32 v106, v114
    v_permlane32_swap_b32 v107, v115
    v_add_f32 v8, v104, v112
    v_add_f32 v9, v105, v113
    v_add_f32 v10, v106, v114
    v_add_f32 v11, v107, v115
    ds_write_b128 v27, v[8:11]
    s_waitcnt lgkmcnt(0)
    s_barrier
    s_cmp_ge_u32 s3, 4
    s_cbranch_scc1 L_end
    ds_read2st64_b32 v[8:9], v28 offset0:0 offset1:4
    ds_read2st64_b32 v[10:11], v28 offset0:8 offset1:12
    ds_read2st64_b32 v[12:13], v28 offset0:16 offset1:20
    ds_read2st64_b32 v[14:15], v28 offset0:24 offset1:28
    s_mov_b32 s44, 0x55555555
    s_mov_b32 s45, 0x55555555
    s_waitcnt lgkmcnt(2)
    v_add_f32 v8, v8, v9
    v_add_f32 v10, v10, v11
    s_waitcnt lgkmcnt(0)
    v_add_f32 v12, v12, v13
    v_add_f32 v14, v14, v15
    v_add_f32 v8, v8, v10
    v_add_f32 v12, v12, v14
    v_add_f32 v8, v8, v12
    s_nop 1
    v_mov_b32_dpp v9, v8 quad_perm:[1,0,3,2] row_mask:0xf bank_mask:0xf
    v_cvt_pk_bf16_f32 v8, v8, v9
    s_mov_b64 exec, s[44:45]
    global_store_dword v29, v8, s[28:29] sc1
    s_mov_b64 exec, -1
    s_branch L_end
L_f1:
    s_mul_i32 s40, s30, 14
    s_add_u32 s43, s43, s40
    s_mul_i32 s40, s3, 229376
    s_lshl_b32 s41, s43, 5
    s_add_u32 s40, s40, s41
    v_lshrrev_b32 v8, 1, v1
    v_mul_u32_u24 v8, 3584, v8
    v_and_b32 v9, 1, v1
    v_lshl_add_u32 v8, v9, 4, v8
    v_add_u32 v8, s40, v8
    v_add_u32 v9, 114688, v8
    s_lshl_b32 s42, s3, 13
    s_add_u32 s42, s42, 40960
    s_add_u32 m0, s42, 0
    s_nop 0
    global_load_lds_dwordx4 v8, s[18:19]
    s_add_u32 m0, s42, 1024
    s_nop 0
    global_load_lds_dwordx4 v9, s[18:19]
    s_add_u32 m0, s42, 2048
    s_nop 0
    global_load_lds_dwordx4 v8, s[20:21]
    s_add_u32 m0, s42, 3072
    s_nop 0
    global_load_lds_dwordx4 v9, s[20:21]
    v_bfe_u32 v8, v1, 2, 2
    v_lshl_add_u32 v8, v3, 3, v8
    v_lshlrev_b32 v8, 5, v8
    v_and_b32 v9, 3, v1
    v_lshl_add_u32 v8, v9, 3, v8
    v_add_u32 v31, s42, v8
    v_and_b32 v8, 3, v2
    v_mul_u32_u24 v8, 1088, v8
    v_lshl_add_u32 v8, v3, 4, v8
    s_lshl_b32 s40, s3, 7
    s_add_u32 s40, s40, 139264
    v_add_u32 v32, s40, v8
    s_lshl_b32 s40, s3, 9
    s_add_u32 s40, s40, 131072
    v_lshlrev_b32 v8, 4, v2
    v_add_u32 v33, s40, v8
    v_lshl_add_u32 v8, v3, 2, v8
    v_add_u32 v34, 131072, v8
    s_lshl_b32 s40, s43, 7
    s_add_u32 s40, s40, 5537792
    v_lshrrev_b32 v8, 3, v2
    v_lshlrev_b32 v8, 6, v8
    v_lshl_add_u32 v8, v3, 4, v8
    v_and_b32 v9, 7, v2
    v_lshl_add_u32 v8, v9, 1, v8
    v_add_u32 v35, s40, v8
    s_cmp_ge_u32 s3, 4
    s_cbranch_scc1 L_f1_w
    s_lshl_b32 s40, s3, 10
    v_lshrrev_b32 v8, 1, v3
    v_lshlrev_b32 v8, 8, v8
    v_lshl_add_u32 v8, v2, 4, v8
    v_and_b32 v9, 1, v3
    v_lshl_add_u32 v30, v9, 3, v8
    v_add_u32 v8, s40, v30
    global_load_dwordx2 v[16:17], v8, s[4:5]
    global_load_dwordx2 v[18:19], v8, s[4:5] offset:512
    v_and_b32 v9, 1, v2
    v_cmp_eq_u32 vcc, 1, v9
    v_mov_b32 v10, 0x3f80
    v_mov_b32 v11, 0x3f800000
    v_cndmask_b32 v10, v10, v11, vcc
    v_lshrrev_b32 v9, 1, v2
    v_cmp_eq_u32 vcc, 0, v9
    s_nop 1
    v_cndmask_b32 v128, 0, v10, vcc
    v_cmp_eq_u32 vcc, 1, v9
    s_nop 1
    v_cndmask_b32 v129, 0, v10, vcc
    v_cmp_eq_u32 vcc, 2, v9
    s_nop 1
    v_cndmask_b32 v130, 0, v10, vcc
    v_cmp_eq_u32 vcc, 3, v9
    s_nop 1
    v_cndmask_b32 v131, 0, v10, vcc
    v_cmp_eq_u32 vcc, 4, v9
    s_nop 1
    v_cndmask_b32 v132, 0, v10, vcc
    v_cmp_eq_u32 vcc, 5, v9
    s_nop 1
    v_cndmask_b32 v133, 0, v10, vcc
    v_cmp_eq_u32 vcc, 6, v9
    s_nop 1
    v_cndmask_b32 v134, 0, v10, vcc
    v_cmp_eq_u32 vcc, 7, v9
    s_nop 1
    v_cndmask_b32 v135, 0, v10, vcc
    s_lshl_b32 s40, s3, 7
    s_add_u32 s40, s40, 5505024
    v_lshrrev_b32 v8, 3, v2
    v_lshlrev_b32 v8, 12, v8
    v_lshl_add_u32 v8, v3, 9, v8
    v_and_b32 v9, 7, v2
    v_lshl_add_u32 v8, v9, 4, v8
    v_add_u32 v26, s40, v8
    v_add_u32 v27, 0x2000, v26
    v_add_u32 v28, 0x4000, v26
    v_add_u32 v29, 0x6000, v26
    s_waitcnt vmcnt(0)
    v_lshlrev_b32 v136, 16, v16
    v_and_b32 v137, 0xffff0000, v16
    v_lshlrev_b32 v138, 16, v17
    v_and_b32 v139, 0xffff0000, v17
    v_lshlrev_b32 v140, 16, v18
    v_and_b32 v141, 0xffff0000, v18
    v_lshlrev_b32 v142, 16, v19
    v_and_b32 v143, 0xffff0000, v19
    s_mul_i32 s40, s3, 1088
    s_add_u32 s40, s40, 139264
    v_add_u32 v30, s40, v30
L_f1_w:
    s_waitcnt vmcnt(0)
    ds_read_b64_tr_b16 v[64:65], v31 offset:0
    ds_read_b64_tr_b16 v[66:67], v31 offset:128
    ds_read_b64_tr_b16 v[68:69], v31 offset:1024
    ds_read_b64_tr_b16 v[70:71], v31 offset:1152
    ds_read_b64_tr_b16 v[72:73], v31 offset:2048
    ds_read_b64_tr_b16 v[74:75], v31 offset:2176
    ds_read_b64_tr_b16 v[76:77], v31 offset:3072
    ds_read_b64_tr_b16 v[78:79], v31 offset:3200
    s_cmp_ge_u32 s3, 4
    s_cbranch_scc1 L_f1_b
    s_and_b32 s40, s43, 7
    s_lshl_b32 s40, s40, 12
    s_lshl_b32 s41, s3, 7
    s_add_u32 s40, s40, s41
    s_add_u32 s40, s40, 5505024
    v_and_b32 v9, 7, v1
    v_lshlrev_b32 v9, 9, v9
    v_add_u32 v9, s40, v9
    s_mov_b32 s33, 0
L_pi6:
    global_load_dword v10, v9, s[28:29] sc1
    s_waitcnt vmcnt(0)
    v_cmp_eq_u32 vcc, -1, v10
    s_cbranch_vccz L_pi6_ok
    s_sleep 2
    s_add_u32 s33, s33, 1
    s_cmp_lt_u32 s33, 65536
    s_cbranch_scc1 L_pi6
L_pi6_ok:
    global_load_dwordx4 v[96:99], v26, s[28:29] offset:0 sc1
    global_load_dwordx4 v[100:103], v26, s[28:29] offset:2048 sc1
    global_load_dwordx4 v[104:107], v27, s[28:29] offset:0 sc1
    global_load_dwordx4 v[108:111], v27, s[28:29] offset:2048 sc1
    global_load_dwordx4 v[112:115], v28, s[28:29] offset:0 sc1
    global_load_dwordx4 v[116:119], v28, s[28:29] offset:2048 sc1
    global_load_dwordx4 v[120:123], v29, s[28:29] offset:0 sc1
    global_load_dwordx4 v[124:127], v29, s[28:29] offset:2048 sc1
    s_mov_b32 s33, 0
L_ph7:
    s_waitcnt vmcnt(0)
    v_max3_u32 v8, v99, v103, v107
    v_max3_u32 v8, v8, v111, v115
    v_max3_u32 v8, v8, v119, v123
    v_max_u32 v8, v8, v127
    v_cmp_eq_u32 vcc, -1, v8
    s_cbranch_vccz L_ph7_ok
    s_add_u32 s33, s33, 1
    s_cmp_ge_u32 s33, 65536
    s_cbranch_scc1 L_ph7_ok
    global_load_dwordx4 v[96:99], v26, s[28:29] offset:0 sc1
    global_load_dwordx4 v[100:103], v26, s[28:29] offset:2048 sc1
    global_load_dwordx4 v[104:107], v27, s[28:29] offset:0 sc1
    global_load_dwordx4 v[108:111], v27, s[28:29] offset:2048 sc1
    global_load_dwordx4 v[112:115], v28, s[28:29] offset:0 sc1
    global_load_dwordx4 v[116:119], v28, s[28:29] offset:2048 sc1
    global_load_dwordx4 v[120:123], v29, s[28:29] offset:0 sc1
    global_load_dwordx4 v[124:127], v29, s[28:29] offset:2048 sc1
    s_branch L_ph7
L_ph7_ok:
    v_mfma_f32_16x16x32_bf16 v[136:139], v[128:131], v[96:99], v[136:139]
    v_mfma_f32_16x16x32_bf16 v[140:143], v[128:131], v[112:115], v[140:143]
    v_mfma_f32_16x16x32_bf16 v[136:139], v[128:131], v[100:103], v[136:139]
    v_mfma_f32_16x16x32_bf16 v[140:143], v[128:131], v[116:119], v[140:143]
    v_mfma_f32_16x16x32_bf16 v[136:139], v[132:135], v[104:107], v[136:139]
    v_mfma_f32_16x16x32_bf16 v[140:143], v[132:135], v[120:123], v[140:143]
    v_mfma_f32_16x16x32_bf16 v[136:139], v[132:135], v[108:111], v[136:139]
    v_mfma_f32_16x16x32_bf16 v[140:143], v[132:135], v[124:127], v[140:143]
    s_nop 6
    v_add_f32 v8, v136, v137
    v_mul_f32 v9, v136, v136
    v_add_f32 v10, v138, v139
    v_fmac_f32 v9, v137, v137
    v_add_f32 v11, v140, v141
    v_fmac_f32 v9, v138, v138
    v_add_f32 v12, v142, v143
    v_fmac_f32 v9, v139, v139
    v_add_f32 v8, v8, v10
    v_fmac_f32 v9, v140, v140
    v_add_f32 v11, v11, v12
    v_fmac_f32 v9, v141, v141
    v_add_f32 v8, v8, v11
    v_fmac_f32 v9, v142, v142
    v_fmac_f32 v9, v143, v143
    v_add_f32_dpp v8, v8, v8 row_ror:1 row_mask:0xf bank_mask:0xf
    s_nop 0
    v_add_f32_dpp v9, v9, v9 row_ror:1 row_mask:0xf bank_mask:0xf
    v_add_f32_dpp v8, v8, v8 row_ror:2 row_mask:0xf bank_mask:0xf
    s_nop 0
    v_add_f32_dpp v9, v9, v9 row_ror:2 row_mask:0xf bank_mask:0xf
    v_add_f32_dpp v8, v8, v8 row_ror:4 row_mask:0xf bank_mask:0xf
    s_nop 0
    v_add_f32_dpp v9, v9, v9 row_ror:4 row_mask:0xf bank_mask:0xf
    v_add_f32_dpp v8, v8, v8 row_ror:8 row_mask:0xf bank_mask:0xf
    s_nop 0
    v_add_f32_dpp v9, v9, v9 row_ror:8 row_mask:0xf bank_mask:0xf
    v_mov_b32 v10, v8
    v_mov_b32 v11, v9
    s_nop 0
    v_permlane16_swap_b32 v10, v8
    v_permlane16_swap_b32 v11, v9
    v_add_f32 v8, v8, v10
    v_add_f32 v9, v9, v11
    v_mov_b32 v10, v8
    v_mov_b32 v11, v9
    s_nop 0
    v_permlane32_swap_b32 v10, v8
    v_permlane32_swap_b32 v11, v9
    v_add_f32 v8, v8, v10
    v_add_f32 v9, v9, v11
    v_mul_f32 v8, 0x3b000000, v8
    v_mul_f32 v9, 0x3b000000, v9
    v_fma_f32 v9, -v8, v8, v9
    v_max_f32 v9, 0, v9
    v_add_f32 v9, 0x3727c5ac, v9
    v_rsq_f32 v9, v9
    v_sub_f32 v12, v136, v8
    v_sub_f32 v13, v137, v8
    v_sub_f32 v14, v138, v8
    v_sub_f32 v15, v139, v8
    v_sub_f32 v16, v140, v8
    v_sub_f32 v17, v141, v8
    v_sub_f32 v18, v142, v8
    v_sub_f32 v19, v143, v8
    v_mul_f32 v12, v12, v9
    v_mul_f32 v13, v13, v9
    v_mul_f32 v14, v14, v9
    v_mul_f32 v15, v15, v9
    v_mul_f32 v16, v16, v9
    v_mul_f32 v17, v17, v9
    v_mul_f32 v18, v18, v9
    v_mul_f32 v19, v19, v9
    v_cvt_pk_bf16_f32 v12, v12, v13
    v_cvt_pk_bf16_f32 v13, v14, v15
    v_cvt_pk_bf16_f32 v14, v16, v17
    v_cvt_pk_bf16_f32 v15, v18, v19
    ds_write_b64 v30, v[12:13]
    ds_write_b64 v30, v[14:15] offset:512
L_f1_b:
    s_waitcnt lgkmcnt(0)
    s_barrier
    ds_read_b128 v[144:147], v32
    ds_read_b128 v[148:151], v32 offset:64
    s_waitcnt lgkmcnt(1)
    v_mfma_f32_16x16x32_bf16 v[172:175], v[144:147], v[64:67], 0
    v_mfma_f32_16x16x32_bf16 v[176:179], v[144:147], v[72:75], 0
    s_waitcnt lgkmcnt(0)
    v_mfma_f32_16x16x32_bf16 v[172:175], v[148:151], v[68:71], v[172:175]
    v_mfma_f32_16x16x32_bf16 v[176:179], v[148:151], v[76:79], v[176:179]
    s_mov_b64 exec, 0xffff
    s_nop 5
    ds_write_b128 v33, v[172:175]
    ds_write_b128 v33, v[176:179] offset:256
    s_mov_b64 exec, -1
    s_waitcnt lgkmcnt(0)
    s_barrier
    s_cmp_lg_u32 s3, 0
    s_cbranch_scc1 L_end
    ds_read2st64_b32 v[8:9], v34 offset0:0 offset1:1
    ds_read2st64_b32 v[10:11], v34 offset0:2 offset1:3
    ds_read2st64_b32 v[12:13], v34 offset0:4 offset1:5
    ds_read2st64_b32 v[14:15], v34 offset0:6 offset1:7
    ds_read2st64_b32 v[16:17], v34 offset0:8 offset1:9
    ds_read2st64_b32 v[18:19], v34 offset0:10 offset1:11
    ds_read2st64_b32 v[20:21], v34 offset0:12 offset1:13
    ds_read2st64_b32 v[22:23], v34 offset0:14 offset1:15
    s_mov_b32 s44, 0x55555555
    s_mov_b32 s45, 0x55555555
    s_mov_b32 s40, 0xbdd2d3e8
    v_mov_b32 v24, 0xc0135761
    s_waitcnt lgkmcnt(4)
    v_add_f32 v8, v8, v10
    v_add_f32 v9, v9, v11
    v_add_f32 v12, v12, v14
    v_add_f32 v13, v13, v15
    s_waitcnt lgkmcnt(0)
    v_add_f32 v16, v16, v18
    v_add_f32 v20, v20, v22
    v_add_f32 v8, v8, v12
    v_add_f32 v16, v16, v20
    v_add_f32 v17, v17, v19
    v_add_f32 v8, v8, v16
    v_add_f32 v21, v21, v23
    v_mul_f32 v10, v8, v8
    v_add_f32 v9, v9, v13
    v_fma_f32 v10, v10, s40, v24
    v_add_f32 v17, v17, v21
    v_mul_f32 v10, v10, v8
    v_add_f32 v9, v9, v17
    v_exp_f32 v10, v10
    v_mul_f32 v8, v8, v9
    v_add_f32 v10, 1.0, v10
    v_rcp_f32 v10, v10
    s_nop 0
    v_mul_f32 v8, v8, v10
    s_nop 1
    v_mov_b32_dpp v9, v8 quad_perm:[1,0,3,2] row_mask:0xf bank_mask:0xf
    v_cvt_pk_bf16_f32 v8, v8, v9
    s_mov_b64 exec, s[44:45]
    global_store_dword v35, v8, s[28:29] sc1
    s_mov_b64 exec, -1
    s_branch L_end
L_f2:
    s_lshl_b32 s40, s30, 2
    s_add_u32 s43, s43, s40
    s_mul_i32 s40, s3, 229376
    s_lshl_b32 s41, s43, 5
    s_add_u32 s40, s40, s41
    v_lshrrev_b32 v8, 1, v1
    v_lshlrev_b32 v8, 10, v8
    v_and_b32 v9, 1, v1
    v_lshl_add_u32 v8, v9, 4, v8
    v_add_u32 v8, s40, v8
    s_lshl_b32 s42, s3, 13
    s_add_u32 s42, s42, 40960
    s_add_u32 m0, s42, 0
    s_nop 0
    global_load_lds_dwordx4 v8, s[22:23]
    s_add_u32 m0, s42, 1024
    v_add_u32 v8, 0x8000, v8
    global_load_lds_dwordx4 v8, s[22:23]
    s_add_u32 m0, s42, 2048
    v_add_u32 v8, 0x8000, v8
    global_load_lds_dwordx4 v8, s[22:23]
    s_add_u32 m0, s42, 3072
    v_add_u32 v8, 0x8000, v8
    global_load_lds_dwordx4 v8, s[22:23]
    s_add_u32 m0, s42, 4096
    v_add_u32 v8, 0x8000, v8
    global_load_lds_dwordx4 v8, s[22:23]
    s_add_u32 m0, s42, 5120
    v_add_u32 v8, 0x8000, v8
    global_load_lds_dwordx4 v8, s[22:23]
    s_add_u32 m0, s42, 6144
    v_add_u32 v8, 0x8000, v8
    global_load_lds_dwordx4 v8, s[22:23]
    v_bfe_u32 v8, v1, 2, 2
    v_lshl_add_u32 v8, v3, 3, v8
    v_lshlrev_b32 v8, 5, v8
    v_and_b32 v9, 3, v1
    v_lshl_add_u32 v8, v9, 3, v8
    v_add_u32 v31, s42, v8
    s_mul_i32 s40, s3, 1792
    s_add_u32 s40, s40, 5537792
    v_and_b32 v8, 3, v2
    v_lshlrev_b32 v8, 4, v8
    v_lshl_add_u32 v8, v3, 6, v8
    v_add_u32 v32, s40, v8
    s_lshl_b32 s40, s3, 8
    s_add_u32 s40, s40, 131072
    v_lshlrev_b32 v8, 4, v2
    v_add_u32 v33, s40, v8
    v_lshl_add_u32 v8, v3, 2, v8
    v_add_u32 v34, 131072, v8
    s_lshl_b32 s40, s43, 6
    s_add_u32 s40, s40, 139264
    v_lshlrev_b32 v8, 11, v3
    v_lshl_add_u32 v8, v2, 2, v8
    v_add_u32 v35, s40, v8
    s_lshl_b32 s40, s43, 5
    v_lshlrev_b32 v8, 10, v3
    v_lshl_add_u32 v8, v2, 1, v8
    v_add_u32 v36, s40, v8
    s_cmp_ge_u32 s3, 4
    s_cbranch_scc1 L_f2_w
    s_lshl_b32 s40, s3, 10
    v_lshrrev_b32 v8, 1, v3
    v_lshlrev_b32 v8, 8, v8
    v_lshl_add_u32 v8, v2, 4, v8
    v_and_b32 v9, 1, v3
    v_lshl_add_u32 v30, v9, 3, v8
    v_add_u32 v8, s40, v30
    global_load_dwordx2 v[16:17], v8, s[4:5]
    global_load_dwordx2 v[18:19], v8, s[4:5] offset:512
    v_and_b32 v9, 1, v2
    v_cmp_eq_u32 vcc, 1, v9
    v_mov_b32 v10, 0x3f80
    v_mov_b32 v11, 0x3f800000
    v_cndmask_b32 v10, v10, v11, vcc
    v_lshrrev_b32 v9, 1, v2
    v_cmp_eq_u32 vcc, 0, v9
    s_nop 1
    v_cndmask_b32 v128, 0, v10, vcc
    v_cmp_eq_u32 vcc, 1, v9
    s_nop 1
    v_cndmask_b32 v129, 0, v10, vcc
    v_cmp_eq_u32 vcc, 2, v9
    s_nop 1
    v_cndmask_b32 v130, 0, v10, vcc
    v_cmp_eq_u32 vcc, 3, v9
    s_nop 1
    v_cndmask_b32 v131, 0, v10, vcc
    v_cmp_eq_u32 vcc, 4, v9
    s_nop 1
    v_cndmask_b32 v132, 0, v10, vcc
    v_cmp_eq_u32 vcc, 5, v9
    s_nop 1
    v_cndmask_b32 v133, 0, v10, vcc
    v_cmp_eq_u32 vcc, 6, v9
    s_nop 1
    v_cndmask_b32 v134, 0, v10, vcc
    v_cmp_eq_u32 vcc, 7, v9
    s_nop 1
    v_cndmask_b32 v135, 0, v10, vcc
    s_lshl_b32 s40, s3, 7
    s_add_u32 s40, s40, 5505024
    v_lshrrev_b32 v8, 3, v2
    v_lshlrev_b32 v8, 12, v8
    v_lshl_add_u32 v8, v3, 9, v8
    v_and_b32 v9, 7, v2
    v_lshl_add_u32 v8, v9, 4, v8
    v_add_u32 v26, s40, v8
    v_add_u32 v27, 0x2000, v26
    v_add_u32 v28, 0x4000, v26
    v_add_u32 v29, 0x6000, v26
    s_waitcnt vmcnt(0)
    v_lshlrev_b32 v136, 16, v16
    v_and_b32 v137, 0xffff0000, v16
    v_lshlrev_b32 v138, 16, v17
    v_and_b32 v139, 0xffff0000, v17
    v_lshlrev_b32 v140, 16, v18
    v_and_b32 v141, 0xffff0000, v18
    v_lshlrev_b32 v142, 16, v19
    v_and_b32 v143, 0xffff0000, v19
    s_lshl_b32 s40, s3, 11
    s_add_u32 s40, s40, 139264
    v_lshlrev_b32 v30, 1, v30
    v_add_u32 v30, s40, v30
L_f2_w:
    s_waitcnt vmcnt(0)
    ds_read_b64_tr_b16 v[64:65], v31 offset:0
    ds_read_b64_tr_b16 v[66:67], v31 offset:128
    ds_read_b64_tr_b16 v[68:69], v31 offset:1024
    ds_read_b64_tr_b16 v[70:71], v31 offset:1152
    ds_read_b64_tr_b16 v[72:73], v31 offset:2048
    ds_read_b64_tr_b16 v[74:75], v31 offset:2176
    ds_read_b64_tr_b16 v[76:77], v31 offset:3072
    ds_read_b64_tr_b16 v[78:79], v31 offset:3200
    ds_read_b64_tr_b16 v[80:81], v31 offset:4096
    ds_read_b64_tr_b16 v[82:83], v31 offset:4224
    ds_read_b64_tr_b16 v[84:85], v31 offset:5120
    ds_read_b64_tr_b16 v[86:87], v31 offset:5248
    ds_read_b64_tr_b16 v[88:89], v31 offset:6144
    ds_read_b64_tr_b16 v[90:91], v31 offset:6272
    s_cmp_ge_u32 s3, 4
    s_cbranch_scc1 L_f2_a
    s_and_b32 s40, s43, 7
    s_lshl_b32 s40, s40, 12
    s_lshl_b32 s41, s3, 7
    s_add_u32 s40, s40, s41
    s_add_u32 s40, s40, 5505024
    v_and_b32 v9, 7, v1
    v_lshlrev_b32 v9, 9, v9
    v_add_u32 v9, s40, v9
    s_mov_b32 s33, 0
L_pi8:
    global_load_dword v10, v9, s[28:29] sc1
    s_waitcnt vmcnt(0)
    v_cmp_eq_u32 vcc, -1, v10
    s_cbranch_vccz L_pi8_ok
    s_sleep 2
    s_add_u32 s33, s33, 1
    s_cmp_lt_u32 s33, 65536
    s_cbranch_scc1 L_pi8
L_pi8_ok:
    global_load_dwordx4 v[96:99], v26, s[28:29] offset:0 sc1
    global_load_dwordx4 v[100:103], v26, s[28:29] offset:2048 sc1
    global_load_dwordx4 v[104:107], v27, s[28:29] offset:0 sc1
    global_load_dwordx4 v[108:111], v27, s[28:29] offset:2048 sc1
    global_load_dwordx4 v[112:115], v28, s[28:29] offset:0 sc1
    global_load_dwordx4 v[116:119], v28, s[28:29] offset:2048 sc1
    global_load_dwordx4 v[120:123], v29, s[28:29] offset:0 sc1
    global_load_dwordx4 v[124:127], v29, s[28:29] offset:2048 sc1
    s_mov_b32 s33, 0
L_ph9:
    s_waitcnt vmcnt(0)
    v_max3_u32 v8, v99, v103, v107
    v_max3_u32 v8, v8, v111, v115
    v_max3_u32 v8, v8, v119, v123
    v_max_u32 v8, v8, v127
    v_cmp_eq_u32 vcc, -1, v8
    s_cbranch_vccz L_ph9_ok
    s_add_u32 s33, s33, 1
    s_cmp_ge_u32 s33, 65536
    s_cbranch_scc1 L_ph9_ok
    global_load_dwordx4 v[96:99], v26, s[28:29] offset:0 sc1
    global_load_dwordx4 v[100:103], v26, s[28:29] offset:2048 sc1
    global_load_dwordx4 v[104:107], v27, s[28:29] offset:0 sc1
    global_load_dwordx4 v[108:111], v27, s[28:29] offset:2048 sc1
    global_load_dwordx4 v[112:115], v28, s[28:29] offset:0 sc1
    global_load_dwordx4 v[116:119], v28, s[28:29] offset:2048 sc1
    global_load_dwordx4 v[120:123], v29, s[28:29] offset:0 sc1
    global_load_dwordx4 v[124:127], v29, s[28:29] offset:2048 sc1
    s_branch L_ph9
L_ph9_ok:
    v_mfma_f32_16x16x32_bf16 v[136:139], v[128:131], v[96:99], v[136:139]
    v_mfma_f32_16x16x32_bf16 v[140:143], v[128:131], v[112:115], v[140:143]
    v_mfma_f32_16x16x32_bf16 v[136:139], v[128:131], v[100:103], v[136:139]
    v_mfma_f32_16x16x32_bf16 v[140:143], v[128:131], v[116:119], v[140:143]
    v_mfma_f32_16x16x32_bf16 v[136:139], v[132:135], v[104:107], v[136:139]
    v_mfma_f32_16x16x32_bf16 v[140:143], v[132:135], v[120:123], v[140:143]
    v_mfma_f32_16x16x32_bf16 v[136:139], v[132:135], v[108:111], v[136:139]
    v_mfma_f32_16x16x32_bf16 v[140:143], v[132:135], v[124:127], v[140:143]
    s_nop 6
    ds_write_b128 v30, v[136:139]
    ds_write_b128 v30, v[140:143] offset:1024
L_f2_a:
    s_barrier
    global_load_dwordx4 v[144:147], v32, s[28:29] offset:0 sc1
    global_load_dwordx4 v[148:151], v32, s[28:29] offset:256 sc1
    global_load_dwordx4 v[152:155], v32, s[28:29] offset:512 sc1
    global_load_dwordx4 v[156:159], v32, s[28:29] offset:768 sc1
    global_load_dwordx4 v[160:163], v32, s[28:29] offset:1024 sc1
    global_load_dwordx4 v[164:167], v32, s[28:29] offset:1280 sc1
    global_load_dwordx4 v[168:171], v32, s[28:29] offset:1536 sc1
    s_mov_b32 s33, 0
L_pa10:
    s_waitcnt vmcnt(0)
    v_max3_u32 v8, v147, v151, v155
    v_max3_u32 v8, v8, v159, v163
    v_max3_u32 v8, v8, v167, v171
    v_cmp_eq_u32 vcc, -1, v8
    s_cbranch_vccz L_pa10_ok
    s_add_u32 s33, s33, 1
    s_cmp_ge_u32 s33, 65536
    s_cbranch_scc1 L_pa10_ok
    global_load_dwordx4 v[144:147], v32, s[28:29] offset:0 sc1
    global_load_dwordx4 v[148:151], v32, s[28:29] offset:256 sc1
    global_load_dwordx4 v[152:155], v32, s[28:29] offset:512 sc1
    global_load_dwordx4 v[156:159], v32, s[28:29] offset:768 sc1
    global_load_dwordx4 v[160:163], v32, s[28:29] offset:1024 sc1
    global_load_dwordx4 v[164:167], v32, s[28:29] offset:1280 sc1
    global_load_dwordx4 v[168:171], v32, s[28:29] offset:1536 sc1
    s_branch L_pa10
L_pa10_ok:
    s_waitcnt lgkmcnt(0)
    v_mfma_f32_16x16x32_bf16 v[172:175], v[144:147], v[64:67], 0
    v_mfma_f32_16x16x32_bf16 v[172:175], v[148:151], v[68:71], v[172:175]
    v_mfma_f32_16x16x32_bf16 v[172:175], v[152:155], v[72:75], v[172:175]
    v_mfma_f32_16x16x32_bf16 v[172:175], v[156:159], v[76:79], v[172:175]
    v_mfma_f32_16x16x32_bf16 v[172:175], v[160:163], v[80:83], v[172:175]
    v_mfma_f32_16x16x32_bf16 v[172:175], v[164:167], v[84:87], v[172:175]
    v_mfma_f32_16x16x32_bf16 v[172:175], v[168:171], v[88:91], v[172:175]
    s_mov_b64 exec, 0xffff
    s_nop 6
    ds_write_b128 v33, v[172:175]
    s_mov_b64 exec, -1
    s_waitcnt lgkmcnt(0)
    s_barrier
    s_cmp_lg_u32 s3, 0
    s_cbranch_scc1 L_end
    ds_read2st64_b32 v[8:9], v34 offset0:0 offset1:1
    ds_read2st64_b32 v[10:11], v34 offset0:2 offset1:3
    ds_read2st64_b32 v[12:13], v34 offset0:4 offset1:5
    ds_read2st64_b32 v[14:15], v34 offset0:6 offset1:7
    ds_read_b32 v16, v35
    s_mov_b32 s44, 0x55555555
    s_mov_b32 s45, 0x55555555
    s_waitcnt lgkmcnt(3)
    v_add_f32 v8, v8, v9
    v_add_f32 v10, v10, v11
    s_waitcnt lgkmcnt(0)
    v_add_f32 v12, v12, v13
    v_add_f32 v14, v14, v15
    v_add_f32 v8, v8, v10
    v_add_f32 v12, v12, v14
    v_add_f32 v8, v8, v16
    v_add_f32 v8, v8, v12
    s_nop 1
    v_mov_b32_dpp v9, v8 quad_perm:[1,0,3,2] row_mask:0xf bank_mask:0xf
    v_cvt_pk_bf16_f32 v8, v8, v9
    s_mov_b64 exec, s[44:45]
    global_store_dword v36, v8, s[24:25]
    s_cmp_lg_u32 s43, 0
    s_cbranch_scc1 L_noep
    s_mov_b64 exec, 1
    v_mov_b32 v10, 0
    v_mov_b32 v11, s32
    global_store_dword v10, v11, s[28:29] sc1
L_noep:
    s_mov_b64 exec, -1
L_end:
L_exit:
    s_endpgm
.section .rodata,"a"
.p2align 6
.amdhsa_kernel sequential_preLN__compressed_kv_cla__geglu_ffn__decode_kernel
  .amdhsa_next_free_vgpr 256
  .amdhsa_next_free_sgpr 64
  .amdhsa_accum_offset 256
  .amdhsa_group_segment_fixed_size 0
  .amdhsa_kernarg_size 104
  .amdhsa_user_sgpr_count 2
  .amdhsa_user_sgpr_kernarg_segment_ptr 1
  .amdhsa_system_sgpr_workgroup_id_x 1
.end_amdhsa_kernel
```
